```python
import torch

def _softmax(x, axis=-1):
    return torch.softmax(x, dim=axis)
def _gelu(x):
    return torch.nn.functional.gelu(x, approximate="tanh")
def _silu(x):
    return torch.nn.functional.silu(x)
def _sigmoid(x):
    return torch.sigmoid(x)
def _layernorm(x, axis=-1, eps=1e-5):
    m = x.mean(dim=axis, keepdim=True)
    v = x.var(dim=axis, keepdim=True, unbiased=False)
    return (x - m) / torch.sqrt(v + eps)
def _scatter_add(tgt, idx, src, axis=0):
    return tgt.clone().index_add_(axis, idx, src)
def _segment_sum(src, seg, n):
    out = torch.zeros((n,) + src.shape[1:], dtype=src.dtype)
    return out.index_add_(0, seg, src)
def _pad(x, pw):
    flat = tuple(v for pair in reversed(pw) for v in pair)
    return torch.nn.functional.pad(x, flat)

kernel_name = 'gated_mix__sliding_local_dilated__mha_block__prompt'

def setup_inputs():

    _w = (lambda a: (lambda t: t.to(torch.bfloat16) if t.is_floating_point() else t)(torch.as_tensor(a)))
    def _A_setup():
        B, S, D = 1, 2048, 640
        return {
            "x": _w((lambda *s: torch.randn(*s, dtype=torch.bfloat16) * 0.05)(B, S, D)),
            "wqkv": _w((lambda *s: torch.randn(*s, dtype=torch.bfloat16) * 1.6)(D, 3 * D)),
            "wo": _w((lambda *s: torch.randn(*s, dtype=torch.bfloat16) * 0.05)(D, D)),
        }
    _A_in = _A_setup()

    def _B_setup():
        B, S, D, H = 1, 2048, 640, 32
        return {
            "x": _w((lambda *s: torch.randn(*s, dtype=torch.bfloat16) * 0.05)(B, S, D)),
            "wqkv": _w((lambda *s: torch.randn(*s, dtype=torch.bfloat16) * 1.6)(D, 3 * D)),
            "wo": _w((lambda *s: torch.randn(*s, dtype=torch.bfloat16) * 0.1)(D, D)),
        }
    _B_in = _B_setup()

    return {
        "A_x": _A_in["x"],
        "A_wqkv": _A_in["wqkv"],
        "A_wo": _A_in["wo"],
        "B_x": _B_in["x"],
        "B_wqkv": _B_in["wqkv"],
        "B_wo": _B_in["wo"],
        "gate_w": _w((lambda *s: torch.randn(*s, dtype=torch.bfloat16) * 0.05)(640) * 16.0),
    }

def reference(A_x, A_wqkv, A_wo, B_x, B_wqkv, B_wo, gate_w):
    def _A_ref(x, wqkv, wo):
        B, S, D = x.shape
        H = 32; Dh = D // H
        W, dil = 8, 2
        qkv = (lambda x, *d: x.permute(*d))((x @ wqkv).reshape(B, S, 3, H, Dh), 2, 0, 3, 1, 4)
        q, k, v = qkv[0], qkv[1], qkv[2]
        scale = Dh ** -0.5
        pos = torch.arange(S)
        off = torch.arange(W) * dil
        idx = pos[:, None] - off[None, :]
        mask = idx >= 0
        idx_c = torch.where(mask, idx, 0).reshape(-1)
        kg = k[:, :, idx_c, :].reshape(B, H, S, W, Dh)
        vg = v[:, :, idx_c, :].reshape(B, H, S, W, Dh)
        logits = torch.einsum("bhsd,bhswd->bhsw", q, kg) * scale
        logits = torch.where(mask[None, None, :, :], logits, -1e9)
        attn = _softmax(logits, axis=-1)
        o = torch.einsum("bhsw,bhswd->bhsd", attn, vg)
        return (lambda x, *d: x.permute(*d))(o, 0, 2, 1, 3).reshape(B, S, D) @ wo

    def _B_ref(x, wqkv, wo):
        B, S, D = x.shape
        H = 32
        Dh = D // H
        qkv = (lambda x, *d: x.permute(*d))((x @ wqkv).reshape(B, S, 3, H, Dh), 2, 0, 3, 1, 4)
        q, k, v = qkv[0], qkv[1], qkv[2]
        scores = torch.einsum("bhqd,bhkd->bhqk", q, k) * (Dh ** -0.5)
        p = _softmax(scores, axis=-1)
        o = torch.einsum("bhqk,bhkd->bhqd", p, v)
        return (lambda x, *d: x.permute(*d))(o, 0, 2, 1, 3).reshape(B, S, D) @ wo

    x = A_x
    g = _sigmoid((x * gate_w).sum(-1, keepdims=True))
    a = _A_ref(x, A_wqkv, A_wo)
    b = _B_ref(x, B_wqkv, B_wo)
    return g * a + (1 - g) * b
```

```asm
; @launch grid=(256,1,1) block=(512,1,1) lds=163840
.amdgcn_target "amdgcn-amd-amdhsa--gfx950"
.text
.globl gated_mix__sliding_local_dilated__mha_block__prompt_kernel
.p2align 8
.type gated_mix__sliding_local_dilated__mha_block__prompt_kernel,@function
gated_mix__sliding_local_dilated__mha_block__prompt_kernel:
    s_cmp_ge_u32 s2, 256
    s_cbranch_scc1 K_END
    s_load_dwordx4 s[4:7], s[0:1], 0
    s_load_dwordx2 s[8:9], s[0:1], 32
    s_load_dwordx4 s[64:67], s[0:1], 64
    s_load_dwordx2 s[52:53], s[0:1], 48
    v_lshrrev_b32 v11, 6, v0
    v_and_b32 v1, 63, v0
    s_and_b32 s39, s2, 7
    v_readfirstlane_b32 s36, v11
    s_lshr_b32 s40, s2, 3
    s_cmp_lt_u32 s40, 30
    s_cbranch_scc1 K_NOCP
    s_getpc_b64 s[42:43]
K_PC:
    v_and_b32 v2, 0x1ff, v0
    v_lshlrev_b32 v2, 6, v2
    v_min_u32 v2, K_END-K_PC, v2
    v_mov_b32 v3, s43
    v_add_co_u32 v2, vcc, s42, v2
    s_nop 1
    v_addc_co_u32 v3, vcc, 0, v3, vcc
    global_load_dword v87, v[2:3], off
K_NOCP:
    v_lshlrev_b32 v88, 4, v1
    v_mov_b32 v94, 0
    v_mov_b32 v90, 0
    v_mov_b32 v91, 0
    v_and_b32 v92, 31, v1
    v_lshrrev_b32 v93, 5, v1
    s_lshr_b32 s41, s39, 1
    s_mul_i32 s41, s41, 30
    s_add_u32 s41, s41, s40
    s_lshr_b32 s38, s41, 3
    s_and_b32 s37, s41, 7
    s_and_b32 s42, s39, 1
    s_lshl_b32 s42, s42, 3
    s_add_u32 s37, s37, s42
    s_lshl_b32 s61, s38, 4
    s_add_u32 s61, s61, s37
    s_cmp_ge_u32 s40, 30
    s_cselect_b32 s61, s2, s61
    s_mul_i32 s49, s38, 3
    s_add_u32 s49, s49, s37
    s_mul_i32 s41, s49, 65
    s_lshr_b32 s41, s41, 9
    s_mul_i32 s41, s41, 8
    s_sub_u32 s49, s49, s41
    s_add_u32 s49, s49, 2
    v_lshrrev_b32 v11, 3, v1
    v_and_b32 v12, 7, v1
    v_lshrrev_b32 v13, 4, v1
    v_xor_b32 v12, v12, v13
    s_lshl_b32 s41, s37, 7
    s_lshl_b32 s42, s36, 4
    s_add_u32 s41, s41, s42
    v_add_u32 v11, s41, v11
    v_mul_u32_u24 v11, 1280, v11
    v_lshl_add_u32 v2, v12, 4, v11
    v_xor_b32 v12, 4, v12
    v_add_u32 v11, 10240, v11
    v_lshl_add_u32 v3, v12, 4, v11
    v_mul_u32_u24 v11, 3840, v13
    v_bfe_u32 v12, v1, 2, 2
    v_xor_b32 v12, v12, v13
    v_lshl_add_u32 v11, v12, 6, v11
    v_and_b32 v12, 3, v1
    v_lshl_add_u32 v11, v12, 4, v11
    s_mul_i32 s43, s36, 30720
    s_lshl_b32 s41, s38, 8
    s_add_u32 s41, s41, s43
    v_add_u32 v4, s41, v11
    v_add_u32 v5, 15360, v4
    s_lshl_b32 s50, s36, 11
    s_waitcnt lgkmcnt(0)
    s_mov_b32 s12, s4
    s_and_b32 s13, s5, 0xffff
    s_mov_b32 s14, 2621440
    s_mov_b32 s15, 0x00020000
    s_mov_b32 s16, s8
    s_and_b32 s17, s9, 0xffff
    s_mov_b32 s18, 2457600
    s_mov_b32 s19, 0x00020000
    s_cmp_ge_u32 s40, 30
    s_cbranch_scc1 K_PRO2
    s_add_u32 m0, s50, 0
    s_mov_b32 s46, 0
    s_mov_b32 s47, 0
    buffer_load_dwordx4 v2, s[12:15], s46 offen lds
    s_add_u32 m0, s50, 1024
    s_nop 0
    buffer_load_dwordx4 v3, s[12:15], s46 offen lds
    s_add_u32 m0, s50, 49152
    s_nop 0
    buffer_load_dwordx4 v4, s[16:19], s47 offen lds
    s_add_u32 m0, s50, 50176
    s_nop 0
    buffer_load_dwordx4 v5, s[16:19], s47 offen lds
    s_barrier
    s_add_u32 m0, s50, 81920
    s_mov_b32 s46, 128
    s_mov_b32 s47, 245760
    buffer_load_dwordx4 v2, s[12:15], s46 offen lds
    s_add_u32 m0, s50, 82944
    s_nop 0
    buffer_load_dwordx4 v3, s[12:15], s46 offen lds
    s_add_u32 m0, s50, 65536
    s_nop 0
    buffer_load_dwordx4 v4, s[16:19], s47 offen lds
    s_add_u32 m0, s50, 66560
    s_nop 0
    buffer_load_dwordx4 v5, s[16:19], s47 offen lds
    s_add_u32 m0, s50, 16384
    s_mov_b32 s48, s49
    s_lshl_b32 s46, s48, 7
    s_mul_i32 s47, s48, 245760
    s_add_u32 s48, s48, 1
    s_cmp_eq_u32 s48, 10
    s_cselect_b32 s48, 2, s48
    buffer_load_dwordx4 v2, s[12:15], s46 offen lds
    s_add_u32 m0, s50, 17408
    s_nop 0
    buffer_load_dwordx4 v3, s[12:15], s46 offen lds
    s_add_u32 m0, s50, 114688
    s_nop 0
    buffer_load_dwordx4 v4, s[16:19], s47 offen lds
    s_add_u32 m0, s50, 115712
    s_nop 0
    buffer_load_dwordx4 v5, s[16:19], s47 offen lds
K_PRO2:
    s_mov_b32 s32, s52
    s_and_b32 s33, s53, 0xffff
    s_mov_b32 s34, 1280
    s_mov_b32 s35, 0x00020000
    s_mov_b32 s24, s66
    s_and_b32 s25, s67, 0xffff
    s_mov_b32 s26, 22814720
    s_mov_b32 s27, 0x00020000
    s_mov_b32 s28, s64
    s_and_b32 s29, s65, 0xffff
    s_mov_b32 s30, 256
    s_mov_b32 s31, 0x00020000
    s_mov_b32 s20, s6
    s_and_b32 s21, s7, 0xffff
    s_mov_b32 s22, 2457600
    s_mov_b32 s23, 0x00020000
    s_lshl_b32 s56, s39, 2
    s_and_b32 s41, s40, 3
    s_add_u32 s56, s56, s41
    s_lshr_b32 s58, s40, 2
    s_lshl_b32 s57, s58, 3
    s_and_b32 s41, s36, 3
    s_lshl_b32 s41, s41, 1
    s_add_u32 s57, s57, s41
    s_mul_i32 s59, s56, 5
    s_add_u32 s59, s59, 1
    s_lshr_b32 s59, s59, 1
    s_lshl_b32 s59, s59, 9
    s_movk_i32 s60, 1024
    s_bitcmp1_b32 s56, 0
    s_cselect_b32 s60, -504, s60
    s_mul_i32 s41, s57, 40960
    s_add_u32 s73, s59, s41
    s_mul_i32 s74, s56, 320
    s_add_u32 s74, s74, s41
    s_lshr_b32 s41, s56, 1
    s_mul_i32 s41, s41, 2560
    s_mul_i32 s42, s57, 81920
    s_add_u32 s41, s41, s42
    s_add_u32 s41, s41, 15728640
    s_cmp_lt_u32 s36, 4
    s_cselect_b32 s42, 40960, 0
    s_add_u32 s41, s41, s42
    s_and_b32 s42, s56, 1
    s_lshl_b32 s52, s42, 10
    s_add_u32 s52, s52, s41
    s_lshl_b32 s53, s42, 3
    s_add_u32 s53, s53, s41
    s_mov_b32 s62, 0x000fffff
    s_mov_b32 s63, 0x000fffff
    s_mul_i32 s41, s56, 20
    s_add_u32 s42, s41, 19
    s_lshr_b32 s41, s41, 7
    s_lshr_b32 s42, s42, 7
    v_mov_b32 v11, s41
    v_mov_b32 v12, s42
    s_cmp_ge_u32 s36, 4
    s_cbranch_scc1 K_FI_H
    v_and_b32 v0, 1, v1
    v_cmp_eq_u32 vcc, 0, v0
    s_lshr_b32 s43, s57, 2
    s_nop 0
    v_cndmask_b32 v11, v12, v11, vcc
    v_lshlrev_b32 v11, 4, v11
    v_add_u32 v0, s43, v11
    s_branch K_FI_E
K_FI_H:
    v_and_b32 v0, 16, v1
    v_cmp_eq_u32 vcc, 0, v0
    s_cmp_ge_u32 s36, 6
    s_cselect_b32 s43, 10, 5
    v_cndmask_b32 v11, v12, v11, vcc
    v_add_u32 v11, s43, v11
    v_and_b32 v12, 15, v1
    v_lshl_add_u32 v0, v11, 4, v12
K_FI_E:
    v_lshlrev_b32 v0, 7, v0
    s_cmp_ge_u32 s40, 30
    s_cbranch_scc1 K_SPARE
    v_bfe_u32 v13, v1, 1, 3
    v_xor_b32 v13, v13, v93
    s_and_b32 s41, s36, 3
    s_lshl_b32 s42, s41, 12
    v_lshlrev_b32 v14, 7, v92
    v_add_u32 v14, s42, v14
    v_xor_b32 v15, 0, v13
    v_lshl_add_u32 v72, v15, 4, v14
    v_add_u32 v76, 81920, v72
    v_xor_b32 v15, 2, v13
    v_lshl_add_u32 v73, v15, 4, v14
    v_add_u32 v77, 81920, v73
    v_xor_b32 v15, 4, v13
    v_lshl_add_u32 v74, v15, 4, v14
    v_add_u32 v78, 81920, v74
    v_xor_b32 v15, 6, v13
    v_lshl_add_u32 v75, v15, 4, v14
    v_add_u32 v79, 81920, v75
    v_bfe_u32 v13, v1, 2, 2
    v_lshl_add_u32 v14, v93, 3, v13
    v_lshlrev_b32 v14, 8, v14
    v_bfe_u32 v15, v1, 4, 1
    v_lshl_add_u32 v14, v15, 5, v14
    v_and_b32 v15, 3, v1
    v_lshl_add_u32 v14, v15, 3, v14
    s_lshr_b32 s43, s36, 2
    s_lshl_b32 s44, s43, 1
    v_xor_b32 v13, s44, v13
    v_lshl_add_u32 v6, v13, 6, v14
    v_xor_b32 v13, 1, v13
    v_lshl_add_u32 v7, v13, 6, v14
    v_add_u32 v8, 65536, v6
    v_add_u32 v9, 65536, v7
    v_add_u32 v14, 131072, v6
    v_add_u32 v15, 131072, v7
    s_mul_i32 s51, s38, 52
    s_lshr_b32 s51, s51, 8
    s_mul_i32 s42, s51, 5
    s_sub_u32 s42, s38, s42
    s_lshl_b32 s42, s42, 7
    s_lshl_b32 s43, s43, 6
    s_add_u32 s42, s42, s43
    s_mul_i32 s55, s51, 2621440
    s_lshl_b32 s43, s37, 2
    s_add_u32 s41, s41, s43
    s_mul_i32 s41, s41, 40960
    s_add_u32 s55, s55, s41
    s_cmp_eq_u32 s51, 0
    s_cselect_b32 s54, 0x3ea52b5c, 1.0
    s_cmp_eq_u32 s51, 2
    s_cselect_b32 s43, 4, 6
    s_lshl_b32 s42, s42, s43
    s_add_u32 s55, s55, s42
    v_mul_u32_u24 v10, 10240, v93
    v_lshl_add_u32 v10, v92, 4, v10
    s_waitcnt vmcnt(8)
    s_barrier
    ds_read_b64_tr_b16 v[16:17], v6 offset:49152
    ds_read_b64_tr_b16 v[18:19], v6 offset:50176
    ds_read_b128 v[96:99], v72 offset:0
    ds_read_b64_tr_b16 v[20:21], v7 offset:49152
    ds_read_b64_tr_b16 v[22:23], v7 offset:50176
    ds_read_b64_tr_b16 v[24:25], v6 offset:53248
    ds_read_b64_tr_b16 v[26:27], v6 offset:54272
    ds_read_b128 v[100:103], v73 offset:0
    ds_read_b64_tr_b16 v[28:29], v7 offset:53248
    ds_read_b64_tr_b16 v[30:31], v7 offset:54272
    s_cmp_eq_u32 s51, 2
    s_cbranch_scc1 K_P1V
K_P1Q:
    s_waitcnt lgkmcnt(5)
    v_mfma_f32_32x32x16_bf16 v[40:55], v[16:19], v[96:99], 0
    ds_read_b64_tr_b16 v[32:33], v6 offset:57344
    ds_read_b64_tr_b16 v[34:35], v6 offset:58368
    ds_read_b128 v[104:107], v74 offset:0
    s_add_u32 m0, s50, 98304
    s_lshl_b32 s46, s48, 7
    s_mul_i32 s47, s48, 245760
    s_add_u32 s48, s48, 1
    s_cmp_eq_u32 s48, 10
    s_cselect_b32 s48, 2, s48
    buffer_load_dwordx4 v2, s[12:15], s46 offen lds
    v_mfma_f32_32x32x16_bf16 v[56:71], v[20:23], v[96:99], 0
    ds_read_b64_tr_b16 v[36:37], v7 offset:57344
    ds_read_b64_tr_b16 v[38:39], v7 offset:58368
    s_waitcnt lgkmcnt(5)
    v_mfma_f32_32x32x16_bf16 v[40:55], v[24:27], v[100:103], v[40:55]
    ds_read_b64_tr_b16 v[16:17], v6 offset:61440
    ds_read_b64_tr_b16 v[18:19], v6 offset:62464
    ds_read_b128 v[108:111], v75 offset:0
    s_add_u32 m0, s50, 99328
    s_nop 0
    buffer_load_dwordx4 v3, s[12:15], s46 offen lds
    v_mfma_f32_32x32x16_bf16 v[56:71], v[28:31], v[100:103], v[56:71]
    ds_read_b64_tr_b16 v[20:21], v7 offset:61440
    ds_read_b64_tr_b16 v[22:23], v7 offset:62464
    s_waitcnt vmcnt(6)
    s_barrier
    s_waitcnt lgkmcnt(5)
    v_mfma_f32_32x32x16_bf16 v[40:55], v[32:35], v[104:107], v[40:55]
    ds_read_b64_tr_b16 v[24:25], v8 offset:0
    ds_read_b64_tr_b16 v[26:27], v8 offset:1024
    ds_read_b128 v[112:115], v76 offset:0
    s_add_u32 m0, s50, 131072
    s_nop 0
    buffer_load_dwordx4 v4, s[16:19], s47 offen lds
    v_mfma_f32_32x32x16_bf16 v[56:71], v[36:39], v[104:107], v[56:71]
    ds_read_b64_tr_b16 v[28:29], v9 offset:0
    ds_read_b64_tr_b16 v[30:31], v9 offset:1024
    s_add_u32 m0, s50, 132096
    s_nop 0
    buffer_load_dwordx4 v5, s[16:19], s47 offen lds
    s_waitcnt lgkmcnt(5)
    v_mfma_f32_32x32x16_bf16 v[40:55], v[16:19], v[108:111], v[40:55]
    ds_read_b64_tr_b16 v[32:33], v8 offset:4096
    ds_read_b64_tr_b16 v[34:35], v8 offset:5120
    ds_read_b128 v[116:119], v77 offset:0
    s_add_u32 m0, s50, 32768
    s_lshl_b32 s46, s48, 7
    s_mul_i32 s47, s48, 245760
    s_add_u32 s48, s48, 1
    s_cmp_eq_u32 s48, 10
    s_cselect_b32 s48, 2, s48
    buffer_load_dwordx4 v2, s[12:15], s46 offen lds
    v_mfma_f32_32x32x16_bf16 v[56:71], v[20:23], v[108:111], v[56:71]
    ds_read_b64_tr_b16 v[36:37], v9 offset:4096
    ds_read_b64_tr_b16 v[38:39], v9 offset:5120
    s_waitcnt lgkmcnt(5)
    v_mfma_f32_32x32x16_bf16 v[40:55], v[24:27], v[112:115], v[40:55]
    ds_read_b64_tr_b16 v[16:17], v8 offset:8192
    ds_read_b64_tr_b16 v[18:19], v8 offset:9216
    ds_read_b128 v[120:123], v78 offset:0
    s_add_u32 m0, s50, 33792
    s_nop 0
    buffer_load_dwordx4 v3, s[12:15], s46 offen lds
    v_mfma_f32_32x32x16_bf16 v[56:71], v[28:31], v[112:115], v[56:71]
    ds_read_b64_tr_b16 v[20:21], v9 offset:8192
    ds_read_b64_tr_b16 v[22:23], v9 offset:9216
    s_waitcnt lgkmcnt(5)
    v_mfma_f32_32x32x16_bf16 v[40:55], v[32:35], v[116:119], v[40:55]
    ds_read_b64_tr_b16 v[24:25], v8 offset:12288
    ds_read_b64_tr_b16 v[26:27], v8 offset:13312
    ds_read_b128 v[124:127], v79 offset:0
    s_add_u32 m0, s50, 147456
    s_nop 0
    buffer_load_dwordx4 v4, s[16:19], s47 offen lds
    v_mfma_f32_32x32x16_bf16 v[56:71], v[36:39], v[116:119], v[56:71]
    ds_read_b64_tr_b16 v[28:29], v9 offset:12288
    ds_read_b64_tr_b16 v[30:31], v9 offset:13312
    s_waitcnt vmcnt(7)
    s_barrier
    s_waitcnt lgkmcnt(5)
    v_mfma_f32_32x32x16_bf16 v[40:55], v[16:19], v[120:123], v[40:55]
    ds_read_b64_tr_b16 v[32:33], v8 offset:49152
    ds_read_b64_tr_b16 v[34:35], v8 offset:50176
    ds_read_b128 v[128:131], v72 offset:16384
    s_add_u32 m0, s50, 148480
    s_nop 0
    buffer_load_dwordx4 v5, s[16:19], s47 offen lds
    v_mfma_f32_32x32x16_bf16 v[56:71], v[20:23], v[120:123], v[56:71]
    ds_read_b64_tr_b16 v[36:37], v9 offset:49152
    ds_read_b64_tr_b16 v[38:39], v9 offset:50176
    s_waitcnt lgkmcnt(5)
    v_mfma_f32_32x32x16_bf16 v[40:55], v[24:27], v[124:127], v[40:55]
    ds_read_b64_tr_b16 v[16:17], v8 offset:53248
    ds_read_b64_tr_b16 v[18:19], v8 offset:54272
    ds_read_b128 v[132:135], v73 offset:16384
    s_add_u32 m0, s50, 0
    s_lshl_b32 s46, s48, 7
    s_mul_i32 s47, s48, 245760
    s_add_u32 s48, s48, 1
    s_cmp_eq_u32 s48, 10
    s_cselect_b32 s48, 2, s48
    buffer_load_dwordx4 v2, s[12:15], s46 offen lds
    v_mfma_f32_32x32x16_bf16 v[56:71], v[28:31], v[124:127], v[56:71]
    ds_read_b64_tr_b16 v[20:21], v9 offset:53248
    ds_read_b64_tr_b16 v[22:23], v9 offset:54272
    s_waitcnt lgkmcnt(5)
    v_mfma_f32_32x32x16_bf16 v[40:55], v[32:35], v[128:131], v[40:55]
    ds_read_b64_tr_b16 v[24:25], v8 offset:57344
    ds_read_b64_tr_b16 v[26:27], v8 offset:58368
    ds_read_b128 v[136:139], v74 offset:16384
    s_add_u32 m0, s50, 1024
    s_nop 0
    buffer_load_dwordx4 v3, s[12:15], s46 offen lds
    v_mfma_f32_32x32x16_bf16 v[56:71], v[36:39], v[128:131], v[56:71]
    ds_read_b64_tr_b16 v[28:29], v9 offset:57344
    ds_read_b64_tr_b16 v[30:31], v9 offset:58368
    s_waitcnt lgkmcnt(5)
    v_mfma_f32_32x32x16_bf16 v[40:55], v[16:19], v[132:135], v[40:55]
    ds_read_b64_tr_b16 v[32:33], v8 offset:61440
    ds_read_b64_tr_b16 v[34:35], v8 offset:62464
    ds_read_b128 v[140:143], v75 offset:16384
    s_add_u32 m0, s50, 49152
    s_nop 0
    buffer_load_dwordx4 v4, s[16:19], s47 offen lds
    v_mfma_f32_32x32x16_bf16 v[56:71], v[20:23], v[132:135], v[56:71]
    ds_read_b64_tr_b16 v[36:37], v9 offset:61440
    ds_read_b64_tr_b16 v[38:39], v9 offset:62464
    s_lshl_b32 s44, s61, 3
    s_add_u32 s44, s44, s36
    s_mul_i32 s44, s44, 1280
    v_mov_b32 v244, 0
    v_mov_b32 v245, 0
    v_mov_b32 v246, 0
    v_mov_b32 v247, 0
    buffer_load_dwordx4 v[240:243], v88, s[12:15], s44 offen
    buffer_load_dwordx4 v[248:251], v88, s[32:35], 0 offen
    buffer_load_dwordx4 v[252:255], v88, s[32:35], 0 offen offset:1024
    s_mov_b64 exec, 0xffff
    buffer_load_dwordx4 v[244:247], v88, s[12:15], s44 offen offset:1024
    s_mov_b64 exec, -1
    s_waitcnt vmcnt(11)
    s_barrier
    s_waitcnt lgkmcnt(5)
    v_mfma_f32_32x32x16_bf16 v[40:55], v[24:27], v[136:139], v[40:55]
    ds_read_b64_tr_b16 v[16:17], v14 offset:0
    ds_read_b64_tr_b16 v[18:19], v14 offset:1024
    ds_read_b128 v[144:147], v76 offset:16384
    s_add_u32 m0, s50, 50176
    s_nop 0
    buffer_load_dwordx4 v5, s[16:19], s47 offen lds
    v_mfma_f32_32x32x16_bf16 v[56:71], v[28:31], v[136:139], v[56:71]
    ds_read_b64_tr_b16 v[20:21], v15 offset:0
    ds_read_b64_tr_b16 v[22:23], v15 offset:1024
    s_waitcnt lgkmcnt(5)
    v_mfma_f32_32x32x16_bf16 v[40:55], v[32:35], v[140:143], v[40:55]
    ds_read_b64_tr_b16 v[24:25], v14 offset:4096
    ds_read_b64_tr_b16 v[26:27], v14 offset:5120
    ds_read_b128 v[148:151], v77 offset:16384
    s_add_u32 m0, s50, 81920
    s_lshl_b32 s46, s48, 7
    s_mul_i32 s47, s48, 245760
    s_add_u32 s48, s48, 1
    s_cmp_eq_u32 s48, 10
    s_cselect_b32 s48, 2, s48
    buffer_load_dwordx4 v2, s[12:15], s46 offen lds
    v_mfma_f32_32x32x16_bf16 v[56:71], v[36:39], v[140:143], v[56:71]
    ds_read_b64_tr_b16 v[28:29], v15 offset:4096
    ds_read_b64_tr_b16 v[30:31], v15 offset:5120
    s_waitcnt lgkmcnt(5)
    v_mfma_f32_32x32x16_bf16 v[40:55], v[16:19], v[144:147], v[40:55]
    ds_read_b64_tr_b16 v[32:33], v14 offset:8192
    ds_read_b64_tr_b16 v[34:35], v14 offset:9216
    ds_read_b128 v[152:155], v78 offset:16384
    s_add_u32 m0, s50, 82944
    s_nop 0
    buffer_load_dwordx4 v3, s[12:15], s46 offen lds
    v_mfma_f32_32x32x16_bf16 v[56:71], v[20:23], v[144:147], v[56:71]
    ds_read_b64_tr_b16 v[36:37], v15 offset:8192
    ds_read_b64_tr_b16 v[38:39], v15 offset:9216
    s_waitcnt lgkmcnt(5)
    v_mfma_f32_32x32x16_bf16 v[40:55], v[24:27], v[148:151], v[40:55]
    ds_read_b64_tr_b16 v[16:17], v14 offset:12288
    ds_read_b64_tr_b16 v[18:19], v14 offset:13312
    ds_read_b128 v[156:159], v79 offset:16384
    s_add_u32 m0, s50, 65536
    s_nop 0
    buffer_load_dwordx4 v4, s[16:19], s47 offen lds
    v_mfma_f32_32x32x16_bf16 v[56:71], v[28:31], v[148:151], v[56:71]
    ds_read_b64_tr_b16 v[20:21], v15 offset:12288
    ds_read_b64_tr_b16 v[22:23], v15 offset:13312
    s_waitcnt vmcnt(11)
    s_barrier
    s_waitcnt lgkmcnt(5)
    v_mfma_f32_32x32x16_bf16 v[40:55], v[32:35], v[152:155], v[40:55]
    ds_read_b64_tr_b16 v[24:25], v14 offset:16384
    ds_read_b64_tr_b16 v[26:27], v14 offset:17408
    ds_read_b128 v[160:163], v72 offset:32768
    s_add_u32 m0, s50, 66560
    s_nop 0
    buffer_load_dwordx4 v5, s[16:19], s47 offen lds
    v_mfma_f32_32x32x16_bf16 v[56:71], v[36:39], v[152:155], v[56:71]
    ds_read_b64_tr_b16 v[28:29], v15 offset:16384
    ds_read_b64_tr_b16 v[30:31], v15 offset:17408
    s_waitcnt lgkmcnt(5)
    v_mfma_f32_32x32x16_bf16 v[40:55], v[16:19], v[156:159], v[40:55]
    ds_read_b64_tr_b16 v[32:33], v14 offset:20480
    ds_read_b64_tr_b16 v[34:35], v14 offset:21504
    ds_read_b128 v[164:167], v73 offset:32768
    s_add_u32 m0, s50, 16384
    s_lshl_b32 s46, s48, 7
    s_mul_i32 s47, s48, 245760
    s_add_u32 s48, s48, 1
    s_cmp_eq_u32 s48, 10
    s_cselect_b32 s48, 2, s48
    buffer_load_dwordx4 v2, s[12:15], s46 offen lds
    v_mfma_f32_32x32x16_bf16 v[56:71], v[20:23], v[156:159], v[56:71]
    ds_read_b64_tr_b16 v[36:37], v15 offset:20480
    ds_read_b64_tr_b16 v[38:39], v15 offset:21504
    s_waitcnt lgkmcnt(5)
    v_mfma_f32_32x32x16_bf16 v[40:55], v[24:27], v[160:163], v[40:55]
    ds_read_b64_tr_b16 v[16:17], v14 offset:24576
    ds_read_b64_tr_b16 v[18:19], v14 offset:25600
    ds_read_b128 v[168:171], v74 offset:32768
    s_add_u32 m0, s50, 17408
    s_nop 0
    buffer_load_dwordx4 v3, s[12:15], s46 offen lds
    v_mfma_f32_32x32x16_bf16 v[56:71], v[28:31], v[160:163], v[56:71]
    ds_read_b64_tr_b16 v[20:21], v15 offset:24576
    ds_read_b64_tr_b16 v[22:23], v15 offset:25600
    s_waitcnt lgkmcnt(5)
    v_mfma_f32_32x32x16_bf16 v[40:55], v[32:35], v[164:167], v[40:55]
    ds_read_b64_tr_b16 v[24:25], v14 offset:28672
    ds_read_b64_tr_b16 v[26:27], v14 offset:29696
    ds_read_b128 v[172:175], v75 offset:32768
    s_add_u32 m0, s50, 114688
    s_nop 0
    buffer_load_dwordx4 v4, s[16:19], s47 offen lds
    v_mfma_f32_32x32x16_bf16 v[56:71], v[36:39], v[164:167], v[56:71]
    ds_read_b64_tr_b16 v[28:29], v15 offset:28672
    ds_read_b64_tr_b16 v[30:31], v15 offset:29696
    v_lshlrev_b32 v80, 3, v1
    v_add_u32 v80, s36, v80
    v_lshrrev_b32 v81, 1, v80
    s_and_b32 s45, s37, 7
    v_lshlrev_b32 v81, 3, v81
    v_add_u32 v81, s45, v81
    v_mul_u32_u24 v81, 3840, v81
    v_and_b32 v80, 1, v80
    v_lshl_add_u32 v81, v80, 7, v81
    s_lshl_b32 s45, s38, 8
    buffer_load_dword v80, v81, s[20:23], s45 offen
    s_waitcnt vmcnt(8)
    s_barrier
    s_waitcnt lgkmcnt(5)
    v_mfma_f32_32x32x16_bf16 v[40:55], v[16:19], v[168:171], v[40:55]
    ds_read_b64_tr_b16 v[32:33], v6 offset:49152
    ds_read_b64_tr_b16 v[34:35], v6 offset:50176
    ds_read_b128 v[176:179], v72 offset:0
    s_add_u32 m0, s50, 115712
    s_nop 0
    buffer_load_dwordx4 v5, s[16:19], s47 offen lds
    v_mfma_f32_32x32x16_bf16 v[56:71], v[20:23], v[168:171], v[56:71]
    ds_read_b64_tr_b16 v[36:37], v7 offset:49152
    ds_read_b64_tr_b16 v[38:39], v7 offset:50176
    s_waitcnt lgkmcnt(5)
    v_mfma_f32_32x32x16_bf16 v[40:55], v[24:27], v[172:175], v[40:55]
    ds_read_b64_tr_b16 v[16:17], v6 offset:53248
    ds_read_b64_tr_b16 v[18:19], v6 offset:54272
    ds_read_b128 v[180:183], v73 offset:0
    s_add_u32 m0, s50, 98304
    s_lshl_b32 s46, s48, 7
    s_mul_i32 s47, s48, 245760
    s_add_u32 s48, s48, 1
    s_cmp_eq_u32 s48, 10
    s_cselect_b32 s48, 2, s48
    buffer_load_dwordx4 v2, s[12:15], s46 offen lds
    v_mfma_f32_32x32x16_bf16 v[56:71], v[28:31], v[172:175], v[56:71]
    ds_read_b64_tr_b16 v[20:21], v7 offset:53248
    ds_read_b64_tr_b16 v[22:23], v7 offset:54272
    s_waitcnt lgkmcnt(5)
    v_mfma_f32_32x32x16_bf16 v[40:55], v[32:35], v[176:179], v[40:55]
    ds_read_b64_tr_b16 v[24:25], v6 offset:57344
    ds_read_b64_tr_b16 v[26:27], v6 offset:58368
    ds_read_b128 v[184:187], v74 offset:0
    s_add_u32 m0, s50, 99328
    s_nop 0
    buffer_load_dwordx4 v3, s[12:15], s46 offen lds
    v_mfma_f32_32x32x16_bf16 v[56:71], v[36:39], v[176:179], v[56:71]
    ds_read_b64_tr_b16 v[28:29], v7 offset:57344
    ds_read_b64_tr_b16 v[30:31], v7 offset:58368
    s_waitcnt lgkmcnt(5)
    v_mfma_f32_32x32x16_bf16 v[40:55], v[16:19], v[180:183], v[40:55]
    ds_read_b64_tr_b16 v[32:33], v6 offset:61440
    ds_read_b64_tr_b16 v[34:35], v6 offset:62464
    ds_read_b128 v[188:191], v75 offset:0
    s_add_u32 m0, s50, 131072
    s_nop 0
    buffer_load_dwordx4 v4, s[16:19], s47 offen lds
    v_mfma_f32_32x32x16_bf16 v[56:71], v[20:23], v[180:183], v[56:71]
    ds_read_b64_tr_b16 v[36:37], v7 offset:61440
    ds_read_b64_tr_b16 v[38:39], v7 offset:62464
    s_waitcnt vmcnt(8)
    s_barrier
    s_waitcnt lgkmcnt(5)
    v_mfma_f32_32x32x16_bf16 v[40:55], v[24:27], v[184:187], v[40:55]
    ds_read_b64_tr_b16 v[16:17], v8 offset:0
    ds_read_b64_tr_b16 v[18:19], v8 offset:1024
    ds_read_b128 v[192:195], v76 offset:0
    s_add_u32 m0, s50, 132096
    s_nop 0
    buffer_load_dwordx4 v5, s[16:19], s47 offen lds
    v_mfma_f32_32x32x16_bf16 v[56:71], v[28:31], v[184:187], v[56:71]
    ds_read_b64_tr_b16 v[20:21], v9 offset:0
    ds_read_b64_tr_b16 v[22:23], v9 offset:1024
    s_waitcnt lgkmcnt(5)
    v_mfma_f32_32x32x16_bf16 v[40:55], v[32:35], v[188:191], v[40:55]
    ds_read_b64_tr_b16 v[24:25], v8 offset:4096
    ds_read_b64_tr_b16 v[26:27], v8 offset:5120
    ds_read_b128 v[196:199], v77 offset:0
    s_add_u32 m0, s50, 32768
    s_lshl_b32 s46, s48, 7
    s_mul_i32 s47, s48, 245760
    s_add_u32 s48, s48, 1
    s_cmp_eq_u32 s48, 10
    s_cselect_b32 s48, 2, s48
    buffer_load_dwordx4 v2, s[12:15], s46 offen lds
    v_mfma_f32_32x32x16_bf16 v[56:71], v[36:39], v[188:191], v[56:71]
    ds_read_b64_tr_b16 v[28:29], v9 offset:4096
    ds_read_b64_tr_b16 v[30:31], v9 offset:5120
    s_waitcnt lgkmcnt(5)
    v_mfma_f32_32x32x16_bf16 v[40:55], v[16:19], v[192:195], v[40:55]
    ds_read_b64_tr_b16 v[32:33], v8 offset:8192
    ds_read_b64_tr_b16 v[34:35], v8 offset:9216
    ds_read_b128 v[200:203], v78 offset:0
    s_add_u32 m0, s50, 33792
    s_nop 0
    buffer_load_dwordx4 v3, s[12:15], s46 offen lds
    v_mfma_f32_32x32x16_bf16 v[56:71], v[20:23], v[192:195], v[56:71]
    ds_read_b64_tr_b16 v[36:37], v9 offset:8192
    ds_read_b64_tr_b16 v[38:39], v9 offset:9216
    s_waitcnt vmcnt(16)
    v_mov_b32 v11, 0
    v_dot2_f32_bf16 v11, v240, v248, v11
    v_dot2_f32_bf16 v11, v241, v249, v11
    v_dot2_f32_bf16 v11, v242, v250, v11
    v_dot2_f32_bf16 v11, v243, v251, v11
    v_dot2_f32_bf16 v11, v244, v252, v11
    v_dot2_f32_bf16 v11, v245, v253, v11
    v_dot2_f32_bf16 v11, v246, v254, v11
    v_dot2_f32_bf16 v11, v247, v255, v11
    s_nop 3
    s_waitcnt lgkmcnt(5)
    v_mfma_f32_32x32x16_bf16 v[40:55], v[24:27], v[196:199], v[40:55]
    ds_read_b64_tr_b16 v[16:17], v8 offset:12288
    ds_read_b64_tr_b16 v[18:19], v8 offset:13312
    ds_read_b128 v[204:207], v79 offset:0
    s_add_u32 m0, s50, 147456
    s_nop 0
    buffer_load_dwordx4 v4, s[16:19], s47 offen lds
    v_mfma_f32_32x32x16_bf16 v[56:71], v[28:31], v[196:199], v[56:71]
    ds_read_b64_tr_b16 v[20:21], v9 offset:12288
    ds_read_b64_tr_b16 v[22:23], v9 offset:13312
    v_add_f32_dpp v11, v11, v11 row_ror:8 row_mask:0xf bank_mask:0xf
    s_nop 1
    v_add_f32_dpp v11, v11, v11 row_ror:4 row_mask:0xf bank_mask:0xf
    s_nop 1
    v_add_f32_dpp v11, v11, v11 row_ror:2 row_mask:0xf bank_mask:0xf
    s_nop 1
    v_add_f32_dpp v11, v11, v11 row_ror:1 row_mask:0xf bank_mask:0xf
    s_nop 1
    s_waitcnt vmcnt(7)
    s_barrier
    s_waitcnt lgkmcnt(5)
    v_mfma_f32_32x32x16_bf16 v[40:55], v[32:35], v[200:203], v[40:55]
    ds_read_b64_tr_b16 v[24:25], v8 offset:49152
    ds_read_b64_tr_b16 v[26:27], v8 offset:50176
    ds_read_b128 v[208:211], v72 offset:16384
    s_add_u32 m0, s50, 148480
    s_nop 0
    buffer_load_dwordx4 v5, s[16:19], s47 offen lds
    v_mfma_f32_32x32x16_bf16 v[56:71], v[36:39], v[200:203], v[56:71]
    ds_read_b64_tr_b16 v[28:29], v9 offset:49152
    ds_read_b64_tr_b16 v[30:31], v9 offset:50176
    s_waitcnt lgkmcnt(5)
    v_mfma_f32_32x32x16_bf16 v[40:55], v[16:19], v[204:207], v[40:55]
    ds_read_b64_tr_b16 v[32:33], v8 offset:53248
    ds_read_b64_tr_b16 v[34:35], v8 offset:54272
    ds_read_b128 v[212:215], v73 offset:16384
    s_add_u32 m0, s50, 49152
    s_mov_b32 s46, 0
    s_mov_b32 s47, 0
    buffer_load_dwordx4 v4, s[20:23], s47 offen lds
    v_mfma_f32_32x32x16_bf16 v[56:71], v[20:23], v[204:207], v[56:71]
    ds_read_b64_tr_b16 v[36:37], v9 offset:53248
    ds_read_b64_tr_b16 v[38:39], v9 offset:54272
    v_readlane_b32 s41, v11, 16
    v_readlane_b32 s42, v11, 32
    v_readlane_b32 s43, v11, 48
    s_nop 1
    v_add_f32 v11, s41, v11
    v_add_f32 v11, s42, v11
    v_add_f32 v11, s43, v11
    v_mul_f32 v11, 0xbfb8aa3b, v11
    v_exp_f32 v11, v11
    s_lshl_b32 s44, s61, 3
    v_add_f32 v11, 1.0, v11
    v_rcp_f32 v11, v11
    s_waitcnt lgkmcnt(5)
    v_mfma_f32_32x32x16_bf16 v[40:55], v[24:27], v[208:211], v[40:55]
    ds_read_b64_tr_b16 v[16:17], v8 offset:57344
    ds_read_b64_tr_b16 v[18:19], v8 offset:58368
    ds_read_b128 v[216:219], v74 offset:16384
    s_add_u32 m0, s50, 50176
    s_nop 0
    buffer_load_dwordx4 v5, s[20:23], s47 offen lds
    v_mfma_f32_32x32x16_bf16 v[56:71], v[28:31], v[208:211], v[56:71]
    ds_read_b64_tr_b16 v[20:21], v9 offset:57344
    ds_read_b64_tr_b16 v[22:23], v9 offset:58368
    s_add_u32 s44, s44, s36
    s_lshl_b32 s44, s44, 2
    s_add_u32 s44, s44, 22609920
    v_mov_b32 v12, 0
    s_mov_b64 exec, 1
    buffer_store_dword v11, v12, s[24:27], s44 offen sc1
    s_mov_b64 exec, -1
    s_waitcnt lgkmcnt(5)
    v_mfma_f32_32x32x16_bf16 v[40:55], v[32:35], v[212:215], v[40:55]
    ds_read_b64_tr_b16 v[24:25], v8 offset:61440
    ds_read_b64_tr_b16 v[26:27], v8 offset:62464
    ds_read_b128 v[220:223], v75 offset:16384
    v_mfma_f32_32x32x16_bf16 v[56:71], v[36:39], v[212:215], v[56:71]
    ds_read_b64_tr_b16 v[28:29], v9 offset:61440
    ds_read_b64_tr_b16 v[30:31], v9 offset:62464
    buffer_load_dwordx2 v[90:91], v94, s[28:31], 0 offen sc1
    s_waitcnt vmcnt(8)
    s_barrier
    s_waitcnt lgkmcnt(5)
    v_mfma_f32_32x32x16_bf16 v[40:55], v[16:19], v[216:219], v[40:55]
    ds_read_b64_tr_b16 v[32:33], v14 offset:0
    ds_read_b64_tr_b16 v[34:35], v14 offset:1024
    ds_read_b128 v[224:227], v76 offset:16384
    s_add_u32 m0, s50, 65536
    s_mov_b32 s46, 128
    s_mov_b32 s47, 245760
    buffer_load_dwordx4 v4, s[20:23], s47 offen lds
    v_mfma_f32_32x32x16_bf16 v[56:71], v[20:23], v[216:219], v[56:71]
    ds_read_b64_tr_b16 v[36:37], v15 offset:0
    ds_read_b64_tr_b16 v[38:39], v15 offset:1024
    s_waitcnt lgkmcnt(5)
    v_mfma_f32_32x32x16_bf16 v[40:55], v[24:27], v[220:223], v[40:55]
    ds_read_b64_tr_b16 v[16:17], v14 offset:4096
    ds_read_b64_tr_b16 v[18:19], v14 offset:5120
    ds_read_b128 v[228:231], v77 offset:16384
    s_add_u32 m0, s50, 66560
    s_nop 0
    buffer_load_dwordx4 v5, s[20:23], s47 offen lds
    v_mfma_f32_32x32x16_bf16 v[56:71], v[28:31], v[220:223], v[56:71]
    ds_read_b64_tr_b16 v[20:21], v15 offset:4096
    ds_read_b64_tr_b16 v[22:23], v15 offset:5120
    s_waitcnt lgkmcnt(5)
    v_mfma_f32_32x32x16_bf16 v[40:55], v[32:35], v[224:227], v[40:55]
    ds_read_b64_tr_b16 v[24:25], v14 offset:8192
    ds_read_b64_tr_b16 v[26:27], v14 offset:9216
    ds_read_b128 v[232:235], v78 offset:16384
    v_mfma_f32_32x32x16_bf16 v[56:71], v[36:39], v[224:227], v[56:71]
    ds_read_b64_tr_b16 v[28:29], v15 offset:8192
    ds_read_b64_tr_b16 v[30:31], v15 offset:9216
    s_waitcnt lgkmcnt(5)
    v_mfma_f32_32x32x16_bf16 v[40:55], v[16:19], v[228:231], v[40:55]
    ds_read_b64_tr_b16 v[32:33], v14 offset:12288
    ds_read_b64_tr_b16 v[34:35], v14 offset:13312
    ds_read_b128 v[236:239], v79 offset:16384
    v_mfma_f32_32x32x16_bf16 v[56:71], v[20:23], v[228:231], v[56:71]
    ds_read_b64_tr_b16 v[36:37], v15 offset:12288
    ds_read_b64_tr_b16 v[38:39], v15 offset:13312
    s_waitcnt vmcnt(6)
    s_barrier
    s_waitcnt lgkmcnt(5)
    v_mfma_f32_32x32x16_bf16 v[40:55], v[24:27], v[232:235], v[40:55]
    ds_read_b64_tr_b16 v[16:17], v14 offset:16384
    ds_read_b64_tr_b16 v[18:19], v14 offset:17408
    ds_read_b128 v[240:243], v72 offset:32768
    s_add_u32 m0, s50, 114688
    s_mov_b32 s48, s49
    s_lshl_b32 s46, s48, 7
    s_mul_i32 s47, s48, 245760
    s_add_u32 s48, s48, 1
    s_cmp_eq_u32 s48, 10
    s_cselect_b32 s48, 2, s48
    buffer_load_dwordx4 v4, s[20:23], s47 offen lds
    v_mfma_f32_32x32x16_bf16 v[56:71], v[28:31], v[232:235], v[56:71]
    ds_read_b64_tr_b16 v[20:21], v15 offset:16384
    ds_read_b64_tr_b16 v[22:23], v15 offset:17408
    s_waitcnt lgkmcnt(5)
    v_mfma_f32_32x32x16_bf16 v[40:55], v[32:35], v[236:239], v[40:55]
    ds_read_b64_tr_b16 v[24:25], v14 offset:20480
    ds_read_b64_tr_b16 v[26:27], v14 offset:21504
    ds_read_b128 v[244:247], v73 offset:32768
    s_add_u32 m0, s50, 115712
    s_nop 0
    buffer_load_dwordx4 v5, s[20:23], s47 offen lds
    v_mfma_f32_32x32x16_bf16 v[56:71], v[36:39], v[236:239], v[56:71]
    ds_read_b64_tr_b16 v[28:29], v15 offset:20480
    ds_read_b64_tr_b16 v[30:31], v15 offset:21504
    s_waitcnt lgkmcnt(5)
    v_mfma_f32_32x32x16_bf16 v[40:55], v[16:19], v[240:243], v[40:55]
    ds_read_b64_tr_b16 v[32:33], v14 offset:24576
    ds_read_b64_tr_b16 v[34:35], v14 offset:25600
    ds_read_b128 v[248:251], v74 offset:32768
    v_mfma_f32_32x32x16_bf16 v[56:71], v[20:23], v[240:243], v[56:71]
    ds_read_b64_tr_b16 v[36:37], v15 offset:24576
    ds_read_b64_tr_b16 v[38:39], v15 offset:25600
    s_waitcnt lgkmcnt(5)
    v_mfma_f32_32x32x16_bf16 v[40:55], v[24:27], v[244:247], v[40:55]
    ds_read_b64_tr_b16 v[16:17], v14 offset:28672
    ds_read_b64_tr_b16 v[18:19], v14 offset:29696
    ds_read_b128 v[252:255], v75 offset:32768
    v_mfma_f32_32x32x16_bf16 v[56:71], v[28:31], v[244:247], v[56:71]
    ds_read_b64_tr_b16 v[20:21], v15 offset:28672
    ds_read_b64_tr_b16 v[22:23], v15 offset:29696
    s_waitcnt vmcnt(6)
    s_barrier
    s_waitcnt lgkmcnt(5)
    v_mfma_f32_32x32x16_bf16 v[40:55], v[32:35], v[248:251], v[40:55]
    ds_read_b64_tr_b16 v[24:25], v6 offset:49152
    ds_read_b64_tr_b16 v[26:27], v6 offset:50176
    ds_read_b64_tr_b16 v[28:29], v7 offset:49152
    s_add_u32 m0, s50, 131072
    s_lshl_b32 s46, s48, 7
    s_mul_i32 s47, s48, 245760
    s_add_u32 s48, s48, 1
    s_cmp_eq_u32 s48, 10
    s_cselect_b32 s48, 2, s48
    buffer_load_dwordx4 v4, s[20:23], s47 offen lds
    v_mfma_f32_32x32x16_bf16 v[56:71], v[36:39], v[248:251], v[56:71]
    ds_read_b64_tr_b16 v[30:31], v7 offset:50176
    s_waitcnt lgkmcnt(4)
    v_mfma_f32_32x32x16_bf16 v[40:55], v[16:19], v[252:255], v[40:55]
    ds_read_b64_tr_b16 v[32:33], v6 offset:53248
    ds_read_b64_tr_b16 v[34:35], v6 offset:54272
    ds_read_b64_tr_b16 v[36:37], v7 offset:53248
    s_add_u32 m0, s50, 132096
    s_nop 0
    buffer_load_dwordx4 v5, s[20:23], s47 offen lds
    v_mfma_f32_32x32x16_bf16 v[56:71], v[20:23], v[252:255], v[56:71]
    ds_read_b64_tr_b16 v[38:39], v7 offset:54272
    s_nop 11
    s_add_u32 s42, s55, 7864320
    v_pk_mul_f32 v[40:41], v[40:41], s[54:55] op_sel_hi:[1,0]
    v_pk_mul_f32 v[42:43], v[42:43], s[54:55] op_sel_hi:[1,0]
    v_pk_mul_f32 v[44:45], v[44:45], s[54:55] op_sel_hi:[1,0]
    v_pk_mul_f32 v[46:47], v[46:47], s[54:55] op_sel_hi:[1,0]
    v_cvt_pk_bf16_f32 v72, v40, v41
    v_cvt_pk_bf16_f32 v73, v42, v43
    v_cvt_pk_bf16_f32 v74, v44, v45
    v_cvt_pk_bf16_f32 v75, v46, v47
    s_nop 1
    v_permlane32_swap_b32 v72, v74
    v_permlane32_swap_b32 v73, v75
    buffer_store_dwordx4 v[72:75], v88, s[24:27], s42 offen offset:0 sc1
    v_pk_mul_f32 v[48:49], v[48:49], s[54:55] op_sel_hi:[1,0]
    v_pk_mul_f32 v[50:51], v[50:51], s[54:55] op_sel_hi:[1,0]
    v_pk_mul_f32 v[52:53], v[52:53], s[54:55] op_sel_hi:[1,0]
    v_pk_mul_f32 v[54:55], v[54:55], s[54:55] op_sel_hi:[1,0]
    v_cvt_pk_bf16_f32 v76, v48, v49
    v_cvt_pk_bf16_f32 v77, v50, v51
    v_cvt_pk_bf16_f32 v78, v52, v53
    v_cvt_pk_bf16_f32 v79, v54, v55
    s_nop 1
    v_permlane32_swap_b32 v76, v78
    v_permlane32_swap_b32 v77, v79
    buffer_store_dwordx4 v[76:79], v88, s[24:27], s42 offen offset:1024 sc1
    v_pk_mul_f32 v[56:57], v[56:57], s[54:55] op_sel_hi:[1,0]
    v_pk_mul_f32 v[58:59], v[58:59], s[54:55] op_sel_hi:[1,0]
    v_pk_mul_f32 v[60:61], v[60:61], s[54:55] op_sel_hi:[1,0]
    v_pk_mul_f32 v[62:63], v[62:63], s[54:55] op_sel_hi:[1,0]
    v_cvt_pk_bf16_f32 v80, v56, v57
    v_cvt_pk_bf16_f32 v81, v58, v59
    v_cvt_pk_bf16_f32 v82, v60, v61
    v_cvt_pk_bf16_f32 v83, v62, v63
    s_nop 1
    v_permlane32_swap_b32 v80, v82
    v_permlane32_swap_b32 v81, v83
    buffer_store_dwordx4 v[80:83], v88, s[24:27], s42 offen offset:2048 sc1
    v_pk_mul_f32 v[64:65], v[64:65], s[54:55] op_sel_hi:[1,0]
    v_pk_mul_f32 v[66:67], v[66:67], s[54:55] op_sel_hi:[1,0]
    v_pk_mul_f32 v[68:69], v[68:69], s[54:55] op_sel_hi:[1,0]
    v_pk_mul_f32 v[70:71], v[70:71], s[54:55] op_sel_hi:[1,0]
    v_cvt_pk_bf16_f32 v84, v64, v65
    v_cvt_pk_bf16_f32 v85, v66, v67
    v_cvt_pk_bf16_f32 v86, v68, v69
    v_cvt_pk_bf16_f32 v87, v70, v71
    s_nop 1
    v_permlane32_swap_b32 v84, v86
    v_permlane32_swap_b32 v85, v87
    buffer_store_dwordx4 v[84:87], v88, s[24:27], s42 offen offset:3072 sc1
    s_waitcnt lgkmcnt(4)
    v_mfma_f32_32x32x16_bf16 v[40:55], v[24:27], v[96:99], 0
    ds_read_b64_tr_b16 v[16:17], v6 offset:57344
    ds_read_b64_tr_b16 v[18:19], v6 offset:58368
    ds_read_b64_tr_b16 v[20:21], v7 offset:57344
    v_mfma_f32_32x32x16_bf16 v[56:71], v[28:31], v[96:99], 0
    ds_read_b64_tr_b16 v[22:23], v7 offset:58368
    s_waitcnt lgkmcnt(4)
    v_mfma_f32_32x32x16_bf16 v[40:55], v[32:35], v[100:103], v[40:55]
    ds_read_b64_tr_b16 v[24:25], v6 offset:61440
    ds_read_b64_tr_b16 v[26:27], v6 offset:62464
    ds_read_b64_tr_b16 v[28:29], v7 offset:61440
    v_mfma_f32_32x32x16_bf16 v[56:71], v[36:39], v[100:103], v[56:71]
    ds_read_b64_tr_b16 v[30:31], v7 offset:62464
    s_waitcnt vmcnt(8)
    s_barrier
    s_waitcnt lgkmcnt(4)
    v_mfma_f32_32x32x16_bf16 v[40:55], v[16:19], v[104:107], v[40:55]
    ds_read_b64_tr_b16 v[32:33], v8 offset:0
    ds_read_b64_tr_b16 v[34:35], v8 offset:1024
    ds_read_b64_tr_b16 v[36:37], v9 offset:0
    s_add_u32 m0, s50, 0
    s_lshl_b32 s46, s48, 7
    s_mul_i32 s47, s48, 245760
    s_add_u32 s48, s48, 1
    s_cmp_eq_u32 s48, 10
    s_cselect_b32 s48, 2, s48
    buffer_load_dwordx4 v4, s[20:23], s47 offen lds
    v_mfma_f32_32x32x16_bf16 v[56:71], v[20:23], v[104:107], v[56:71]
    ds_read_b64_tr_b16 v[38:39], v9 offset:1024
    s_waitcnt lgkmcnt(4)
    v_mfma_f32_32x32x16_bf16 v[40:55], v[24:27], v[108:111], v[40:55]
    ds_read_b64_tr_b16 v[16:17], v8 offset:4096
    ds_read_b64_tr_b16 v[18:19], v8 offset:5120
    ds_read_b64_tr_b16 v[20:21], v9 offset:4096
    v_mfma_f32_32x32x16_bf16 v[56:71], v[28:31], v[108:111], v[56:71]
    ds_read_b64_tr_b16 v[22:23], v9 offset:5120
    s_waitcnt lgkmcnt(4)
    v_mfma_f32_32x32x16_bf16 v[40:55], v[32:35], v[112:115], v[40:55]
    ds_read_b64_tr_b16 v[24:25], v8 offset:8192
    ds_read_b64_tr_b16 v[26:27], v8 offset:9216
    ds_read_b64_tr_b16 v[28:29], v9 offset:8192
    s_add_u32 m0, s50, 1024
    s_nop 0
    buffer_load_dwordx4 v5, s[20:23], s47 offen lds
    v_mfma_f32_32x32x16_bf16 v[56:71], v[36:39], v[112:115], v[56:71]
    ds_read_b64_tr_b16 v[30:31], v9 offset:9216
    s_waitcnt lgkmcnt(4)
    v_mfma_f32_32x32x16_bf16 v[40:55], v[16:19], v[116:119], v[40:55]
    ds_read_b64_tr_b16 v[32:33], v8 offset:12288
    ds_read_b64_tr_b16 v[34:35], v8 offset:13312
    ds_read_b64_tr_b16 v[36:37], v9 offset:12288
    v_mfma_f32_32x32x16_bf16 v[56:71], v[20:23], v[116:119], v[56:71]
    ds_read_b64_tr_b16 v[38:39], v9 offset:13312
    s_waitcnt vmcnt(8)
    s_barrier
    s_waitcnt lgkmcnt(4)
    v_mfma_f32_32x32x16_bf16 v[40:55], v[24:27], v[120:123], v[40:55]
    ds_read_b64_tr_b16 v[16:17], v8 offset:49152
    ds_read_b64_tr_b16 v[18:19], v8 offset:50176
    ds_read_b64_tr_b16 v[20:21], v9 offset:49152
    s_add_u32 m0, s50, 81920
    s_lshl_b32 s46, s48, 7
    s_mul_i32 s47, s48, 245760
    s_add_u32 s48, s48, 1
    s_cmp_eq_u32 s48, 10
    s_cselect_b32 s48, 2, s48
    buffer_load_dwordx4 v4, s[20:23], s47 offen lds
    v_mfma_f32_32x32x16_bf16 v[56:71], v[28:31], v[120:123], v[56:71]
    ds_read_b64_tr_b16 v[22:23], v9 offset:50176
    s_waitcnt lgkmcnt(4)
    v_mfma_f32_32x32x16_bf16 v[40:55], v[32:35], v[124:127], v[40:55]
    ds_read_b64_tr_b16 v[24:25], v8 offset:53248
    ds_read_b64_tr_b16 v[26:27], v8 offset:54272
    ds_read_b64_tr_b16 v[28:29], v9 offset:53248
    v_mfma_f32_32x32x16_bf16 v[56:71], v[36:39], v[124:127], v[56:71]
    ds_read_b64_tr_b16 v[30:31], v9 offset:54272
    s_waitcnt lgkmcnt(4)
    v_mfma_f32_32x32x16_bf16 v[40:55], v[16:19], v[128:131], v[40:55]
    ds_read_b64_tr_b16 v[32:33], v8 offset:57344
    ds_read_b64_tr_b16 v[34:35], v8 offset:58368
    ds_read_b64_tr_b16 v[36:37], v9 offset:57344
    s_add_u32 m0, s50, 82944
    s_nop 0
    buffer_load_dwordx4 v5, s[20:23], s47 offen lds
    v_mfma_f32_32x32x16_bf16 v[56:71], v[20:23], v[128:131], v[56:71]
    ds_read_b64_tr_b16 v[38:39], v9 offset:58368
    s_waitcnt lgkmcnt(4)
    v_mfma_f32_32x32x16_bf16 v[40:55], v[24:27], v[132:135], v[40:55]
    ds_read_b64_tr_b16 v[16:17], v8 offset:61440
    ds_read_b64_tr_b16 v[18:19], v8 offset:62464
    ds_read_b64_tr_b16 v[20:21], v9 offset:61440
    v_mfma_f32_32x32x16_bf16 v[56:71], v[28:31], v[132:135], v[56:71]
    ds_read_b64_tr_b16 v[22:23], v9 offset:62464
    s_waitcnt vmcnt(8)
    s_barrier
    s_waitcnt lgkmcnt(4)
    v_mfma_f32_32x32x16_bf16 v[40:55], v[32:35], v[136:139], v[40:55]
    ds_read_b64_tr_b16 v[24:25], v14 offset:0
    ds_read_b64_tr_b16 v[26:27], v14 offset:1024
    ds_read_b64_tr_b16 v[28:29], v15 offset:0
    s_add_u32 m0, s50, 16384
    s_lshl_b32 s46, s48, 7
    s_mul_i32 s47, s48, 245760
    s_add_u32 s48, s48, 1
    s_cmp_eq_u32 s48, 10
    s_cselect_b32 s48, 2, s48
    buffer_load_dwordx4 v4, s[20:23], s47 offen lds
    v_mfma_f32_32x32x16_bf16 v[56:71], v[36:39], v[136:139], v[56:71]
    ds_read_b64_tr_b16 v[30:31], v15 offset:1024
    s_waitcnt lgkmcnt(4)
    v_mfma_f32_32x32x16_bf16 v[40:55], v[16:19], v[140:143], v[40:55]
    ds_read_b64_tr_b16 v[32:33], v14 offset:4096
    ds_read_b64_tr_b16 v[34:35], v14 offset:5120
    ds_read_b64_tr_b16 v[36:37], v15 offset:4096
    v_mfma_f32_32x32x16_bf16 v[56:71], v[20:23], v[140:143], v[56:71]
    ds_read_b64_tr_b16 v[38:39], v15 offset:5120
    s_waitcnt lgkmcnt(4)
    v_mfma_f32_32x32x16_bf16 v[40:55], v[24:27], v[144:147], v[40:55]
    ds_read_b64_tr_b16 v[16:17], v14 offset:8192
    ds_read_b64_tr_b16 v[18:19], v14 offset:9216
    ds_read_b64_tr_b16 v[20:21], v15 offset:8192
    s_add_u32 m0, s50, 17408
    s_nop 0
    buffer_load_dwordx4 v5, s[20:23], s47 offen lds
    v_mfma_f32_32x32x16_bf16 v[56:71], v[28:31], v[144:147], v[56:71]
    ds_read_b64_tr_b16 v[22:23], v15 offset:9216
    s_waitcnt lgkmcnt(4)
    v_mfma_f32_32x32x16_bf16 v[40:55], v[32:35], v[148:151], v[40:55]
    ds_read_b64_tr_b16 v[24:25], v14 offset:12288
    ds_read_b64_tr_b16 v[26:27], v14 offset:13312
    ds_read_b64_tr_b16 v[28:29], v15 offset:12288
    v_mfma_f32_32x32x16_bf16 v[56:71], v[36:39], v[148:151], v[56:71]
    ds_read_b64_tr_b16 v[30:31], v15 offset:13312
    s_waitcnt vmcnt(4)
    s_barrier
    s_mov_b32 s45, 0
    s_branch K_P1Q_NG_C
K_P1Q_NG:
    s_sleep 2
    buffer_load_dwordx2 v[90:91], v94, s[28:31], 0 offen sc1
    s_waitcnt vmcnt(0)
K_P1Q_NG_C:
    v_readfirstlane_b32 s10, v90
    v_readfirstlane_b32 s11, v91
    s_add_u32 s45, s45, 1
    s_cmp_gt_u32 s45, 0x40000
    s_cbranch_scc1 K_P1Q_NG_D
    s_min_u32 s44, s10, s11
    s_cmp_eq_u32 s44, 0
    s_cbranch_scc1 K_P1Q_NG
K_P1Q_NG_D:
    s_cmp_lg_u32 s36, 0
    s_cbranch_scc1 K_P1Q_F1
    v_mov_b32 v90, s10
    v_mov_b32 v91, s11
    s_lshl_b32 s45, s61, 7
    s_add_u32 s45, s45, 22618112
    s_mov_b64 exec, 1
    buffer_store_dwordx2 v[90:91], v94, s[24:27], s45 offen sc1
    s_mov_b64 exec, -1
K_P1Q_F1:
    s_waitcnt lgkmcnt(4)
    v_mfma_f32_32x32x16_bf16 v[40:55], v[16:19], v[152:155], v[40:55]
    ds_read_b64_tr_b16 v[32:33], v6 offset:0
    ds_read_b64_tr_b16 v[34:35], v6 offset:1024
    ds_read_b64_tr_b16 v[36:37], v7 offset:0
    s_add_u32 m0, s50, 147456
    s_lshl_b32 s46, s48, 7
    s_mul_i32 s47, s48, 245760
    s_add_u32 s48, s48, 1
    s_cmp_eq_u32 s48, 10
    s_cselect_b32 s48, 2, s48
    buffer_load_dwordx4 v4, s[20:23], s47 offen lds
    v_mfma_f32_32x32x16_bf16 v[56:71], v[20:23], v[152:155], v[56:71]
    ds_read_b64_tr_b16 v[38:39], v7 offset:1024
    s_waitcnt lgkmcnt(4)
    v_mfma_f32_32x32x16_bf16 v[40:55], v[24:27], v[156:159], v[40:55]
    ds_read_b64_tr_b16 v[16:17], v6 offset:4096
    ds_read_b64_tr_b16 v[18:19], v6 offset:5120
    ds_read_b64_tr_b16 v[20:21], v7 offset:4096
    v_mfma_f32_32x32x16_bf16 v[56:71], v[28:31], v[156:159], v[56:71]
    ds_read_b64_tr_b16 v[22:23], v7 offset:5120
    s_waitcnt lgkmcnt(4)
    v_mfma_f32_32x32x16_bf16 v[40:55], v[32:35], v[160:163], v[40:55]
    ds_read_b64_tr_b16 v[24:25], v6 offset:8192
    ds_read_b64_tr_b16 v[26:27], v6 offset:9216
    ds_read_b64_tr_b16 v[28:29], v7 offset:8192
    s_add_u32 m0, s50, 148480
    s_nop 0
    buffer_load_dwordx4 v5, s[20:23], s47 offen lds
    v_mfma_f32_32x32x16_bf16 v[56:71], v[36:39], v[160:163], v[56:71]
    ds_read_b64_tr_b16 v[30:31], v7 offset:9216
    s_waitcnt lgkmcnt(4)
    v_mfma_f32_32x32x16_bf16 v[40:55], v[16:19], v[164:167], v[40:55]
    ds_read_b64_tr_b16 v[32:33], v6 offset:12288
    ds_read_b64_tr_b16 v[34:35], v6 offset:13312
    ds_read_b64_tr_b16 v[36:37], v7 offset:12288
    v_mfma_f32_32x32x16_bf16 v[56:71], v[20:23], v[164:167], v[56:71]
    ds_read_b64_tr_b16 v[38:39], v7 offset:13312
    s_waitcnt vmcnt(4)
    s_barrier
    s_waitcnt lgkmcnt(4)
    v_mfma_f32_32x32x16_bf16 v[40:55], v[24:27], v[168:171], v[40:55]
    ds_read_b64_tr_b16 v[16:17], v8 offset:16384
    ds_read_b64_tr_b16 v[18:19], v8 offset:17408
    ds_read_b64_tr_b16 v[20:21], v9 offset:16384
    s_add_u32 m0, s50, 32768
    s_lshl_b32 s46, s48, 7
    s_mul_i32 s47, s48, 245760
    s_add_u32 s48, s48, 1
    s_cmp_eq_u32 s48, 10
    s_cselect_b32 s48, 2, s48
    buffer_load_dwordx4 v4, s[20:23], s47 offen lds
    v_mfma_f32_32x32x16_bf16 v[56:71], v[28:31], v[168:171], v[56:71]
    ds_read_b64_tr_b16 v[22:23], v9 offset:17408
    s_waitcnt lgkmcnt(4)
    v_mfma_f32_32x32x16_bf16 v[40:55], v[32:35], v[172:175], v[40:55]
    ds_read_b64_tr_b16 v[24:25], v8 offset:20480
    ds_read_b64_tr_b16 v[26:27], v8 offset:21504
    ds_read_b64_tr_b16 v[28:29], v9 offset:20480
    v_mfma_f32_32x32x16_bf16 v[56:71], v[36:39], v[172:175], v[56:71]
    ds_read_b64_tr_b16 v[30:31], v9 offset:21504
    s_waitcnt lgkmcnt(4)
    v_mfma_f32_32x32x16_bf16 v[40:55], v[16:19], v[176:179], v[40:55]
    ds_read_b64_tr_b16 v[32:33], v8 offset:24576
    ds_read_b64_tr_b16 v[34:35], v8 offset:25600
    ds_read_b64_tr_b16 v[36:37], v9 offset:24576
    s_add_u32 m0, s50, 33792
    s_nop 0
    buffer_load_dwordx4 v5, s[20:23], s47 offen lds
    v_mfma_f32_32x32x16_bf16 v[56:71], v[20:23], v[176:179], v[56:71]
    ds_read_b64_tr_b16 v[38:39], v9 offset:25600
    s_waitcnt lgkmcnt(4)
    v_mfma_f32_32x32x16_bf16 v[40:55], v[24:27], v[180:183], v[40:55]
    ds_read_b64_tr_b16 v[16:17], v8 offset:28672
    ds_read_b64_tr_b16 v[18:19], v8 offset:29696
    ds_read_b64_tr_b16 v[20:21], v9 offset:28672
    v_mfma_f32_32x32x16_bf16 v[56:71], v[28:31], v[180:183], v[56:71]
    ds_read_b64_tr_b16 v[22:23], v9 offset:29696
    s_waitcnt vmcnt(4)
    s_barrier
    s_waitcnt lgkmcnt(4)
    v_mfma_f32_32x32x16_bf16 v[40:55], v[32:35], v[184:187], v[40:55]
    ds_read_b64_tr_b16 v[24:25], v6 offset:16384
    ds_read_b64_tr_b16 v[26:27], v6 offset:17408
    ds_read_b64_tr_b16 v[28:29], v7 offset:16384
    s_add_u32 m0, s50, 49152
    s_lshl_b32 s46, s48, 7
    s_mul_i32 s47, s48, 245760
    s_add_u32 s48, s48, 1
    s_cmp_eq_u32 s48, 10
    s_cselect_b32 s48, 2, s48
    buffer_load_dwordx4 v4, s[20:23], s47 offen lds
    v_mfma_f32_32x32x16_bf16 v[56:71], v[36:39], v[184:187], v[56:71]
    ds_read_b64_tr_b16 v[30:31], v7 offset:17408
    s_waitcnt lgkmcnt(4)
    v_mfma_f32_32x32x16_bf16 v[40:55], v[16:19], v[188:191], v[40:55]
    ds_read_b64_tr_b16 v[32:33], v6 offset:20480
    ds_read_b64_tr_b16 v[34:35], v6 offset:21504
    ds_read_b64_tr_b16 v[36:37], v7 offset:20480
    v_mfma_f32_32x32x16_bf16 v[56:71], v[20:23], v[188:191], v[56:71]
    ds_read_b64_tr_b16 v[38:39], v7 offset:21504
    s_waitcnt lgkmcnt(4)
    v_mfma_f32_32x32x16_bf16 v[40:55], v[24:27], v[192:195], v[40:55]
    ds_read_b64_tr_b16 v[16:17], v6 offset:24576
    ds_read_b64_tr_b16 v[18:19], v6 offset:25600
    ds_read_b64_tr_b16 v[20:21], v7 offset:24576
    s_add_u32 m0, s50, 50176
    s_nop 0
    buffer_load_dwordx4 v5, s[20:23], s47 offen lds
    v_mfma_f32_32x32x16_bf16 v[56:71], v[28:31], v[192:195], v[56:71]
    ds_read_b64_tr_b16 v[22:23], v7 offset:25600
    s_waitcnt lgkmcnt(4)
    v_mfma_f32_32x32x16_bf16 v[40:55], v[32:35], v[196:199], v[40:55]
    ds_read_b64_tr_b16 v[24:25], v6 offset:28672
    ds_read_b64_tr_b16 v[26:27], v6 offset:29696
    ds_read_b64_tr_b16 v[28:29], v7 offset:28672
    v_mfma_f32_32x32x16_bf16 v[56:71], v[36:39], v[196:199], v[56:71]
    ds_read_b64_tr_b16 v[30:31], v7 offset:29696
    s_mov_b32 s44, 22618112
    buffer_load_dwordx2 v[136:137], v0, s[24:27], s44 offen sc1
    s_waitcnt vmcnt(4)
    s_barrier
    s_waitcnt lgkmcnt(4)
    v_mfma_f32_32x32x16_bf16 v[40:55], v[16:19], v[200:203], v[40:55]
    ds_read_b64_tr_b16 v[32:33], v14 offset:16384
    ds_read_b64_tr_b16 v[34:35], v14 offset:17408
    ds_read_b64_tr_b16 v[36:37], v15 offset:16384
    v_mfma_f32_32x32x16_bf16 v[56:71], v[20:23], v[200:203], v[56:71]
    ds_read_b64_tr_b16 v[38:39], v15 offset:17408
    s_waitcnt lgkmcnt(4)
    v_mfma_f32_32x32x16_bf16 v[40:55], v[24:27], v[204:207], v[40:55]
    ds_read_b64_tr_b16 v[16:17], v14 offset:20480
    ds_read_b64_tr_b16 v[18:19], v14 offset:21504
    ds_read_b64_tr_b16 v[20:21], v15 offset:20480
    v_mfma_f32_32x32x16_bf16 v[56:71], v[28:31], v[204:207], v[56:71]
    ds_read_b64_tr_b16 v[22:23], v15 offset:21504
    s_waitcnt lgkmcnt(4)
    v_mfma_f32_32x32x16_bf16 v[40:55], v[32:35], v[208:211], v[40:55]
    ds_read_b64_tr_b16 v[24:25], v14 offset:24576
    ds_read_b64_tr_b16 v[26:27], v14 offset:25600
    ds_read_b64_tr_b16 v[28:29], v15 offset:24576
    v_mfma_f32_32x32x16_bf16 v[56:71], v[36:39], v[208:211], v[56:71]
    ds_read_b64_tr_b16 v[30:31], v15 offset:25600
    s_waitcnt lgkmcnt(4)
    v_mfma_f32_32x32x16_bf16 v[40:55], v[16:19], v[212:215], v[40:55]
    ds_read_b64_tr_b16 v[32:33], v14 offset:28672
    ds_read_b64_tr_b16 v[34:35], v14 offset:29696
    ds_read_b64_tr_b16 v[36:37], v15 offset:28672
    v_mfma_f32_32x32x16_bf16 v[56:71], v[20:23], v[212:215], v[56:71]
    ds_read_b64_tr_b16 v[38:39], v15 offset:29696
    s_waitcnt vmcnt(0)
    s_barrier
    s_waitcnt lgkmcnt(4)
    v_mfma_f32_32x32x16_bf16 v[40:55], v[24:27], v[216:219], v[40:55]
    ds_read_b64_tr_b16 v[16:17], v6 offset:32768
    ds_read_b64_tr_b16 v[18:19], v6 offset:33792
    ds_read_b64_tr_b16 v[20:21], v7 offset:32768
    v_mfma_f32_32x32x16_bf16 v[56:71], v[28:31], v[216:219], v[56:71]
    ds_read_b64_tr_b16 v[22:23], v7 offset:33792
    s_mov_b32 s71, 0
    s_cmp_ge_u32 s36, 4
    s_cbranch_scc1 K_P1Q_PH
    s_waitcnt vmcnt(0)
    v_xor_b32 v136, s10, v136
    v_xor_b32 v137, s11, v137
    v_or_b32 v136, v136, v137
    v_cmp_ne_u32 vcc, 0, v136
    s_add_u32 s45, s45, 1
    s_cmp_eq_u64 vcc, 0
    s_cbranch_scc0 K_P1Q_NOPF
    v_mov_b32 v100, 0
    v_mov_b32 v101, 0
    v_mov_b32 v102, 0
    v_mov_b32 v103, 0
    s_add_u32 s44, s73, 7864320
    buffer_load_dwordx4 v[96:99], v88, s[24:27], s44 offen sc1
    s_add_u32 s45, s44, s60
    s_mov_b32 exec_hi, 0
    buffer_load_dwordx2 v[100:101], v88, s[24:27], s45 offen sc1
    s_mov_b32 exec_hi, -1
    s_add_u32 s44, s73, 7905280
    buffer_load_dwordx4 v[104:107], v88, s[24:27], s44 offen sc1
    s_add_u32 s45, s44, s60
    s_mov_b32 exec_hi, 0
    buffer_load_dwordx2 v[102:103], v88, s[24:27], s45 offen sc1
    s_mov_b32 exec_hi, -1
    s_mov_b32 s71, 1
    s_branch K_P1Q_NOPF
K_P1Q_PH:
    s_waitcnt vmcnt(0)
    v_xor_b32 v136, s10, v136
    v_xor_b32 v137, s11, v137
    v_or_b32 v136, v136, v137
    v_cmp_ne_u32 vcc, 0, v136
    s_cmp_ge_u32 s36, 6
    s_cbranch_scc1 K_P1Q_HS_V
    v_mov_b32 v90, v88
    v_lshrrev_b32 v91, 1, v1
    v_and_b32 v89, 1, v1
    v_lshlrev_b32 v89, 2, v89
    v_lshl_add_u32 v91, v91, 4, v89
    s_add_u32 s46, s59, 10485760
    s_add_u32 s47, s46, s60
    s_sub_u32 s47, s47, 1024
    s_mov_b32 s48, 0
    s_branch K_P1Q_HS_G
K_P1Q_HS_V:
    v_mul_u32_u24 v91, 13, v1
    v_lshrrev_b32 v91, 8, v91
    v_mul_u32_u24 v89, 20, v91
    v_sub_u32 v89, v1, v89
    v_mul_u32_u24 v91, 10240, v91
    v_lshl_add_u32 v90, v89, 4, v91
    v_lshlrev_b32 v91, 2, v1
    s_mul_i32 s46, s56, 320
    s_add_u32 s46, s46, 13107200
    s_add_u32 s47, s46, 29760
    s_mov_b32 s48, 81920
K_P1Q_HS_G:
    s_and_b32 s44, s36, 1
    s_mul_i32 s45, s44, 163840
    s_add_u32 s46, s46, s45
    s_add_u32 s47, s47, s45
    s_mul_i32 s45, s44, 5120
    s_add_u32 s48, s48, s45
    s_lshl_b32 s51, 0x10001, s44
    s_mov_b32 s49, 0
    s_mov_b32 s50, vcc_lo
    s_mov_b32 s45, 0
K_P1Q_RU:
    s_cmp_ge_u32 s49, 1
    s_cbranch_scc1 K_P1Q_RU_D
    s_and_b32 s44, s50, s51
    s_cbranch_scc0 K_P1Q_RU_G
    s_branch K_P1Q_RU_D
K_P1Q_RU_G:
    s_add_u32 m0, s48, 0
    s_nop 0
    buffer_load_dwordx4 v90, s[24:27], s46 offen sc1 lds
    buffer_load_dword v91, s[24:27], s47 offen offset:1024 sc1 lds
    s_add_u32 s46, s46, 40960
    s_add_u32 s47, s47, 40960
    s_add_u32 m0, s48, 1280
    s_nop 0
    buffer_load_dwordx4 v90, s[24:27], s46 offen sc1 lds
    buffer_load_dword v91, s[24:27], s47 offen offset:1024 sc1 lds
    s_add_u32 s46, s46, 40960
    s_add_u32 s47, s47, 40960
    s_add_u32 m0, s48, 2560
    s_nop 0
    buffer_load_dwordx4 v90, s[24:27], s46 offen sc1 lds
    buffer_load_dword v91, s[24:27], s47 offen offset:1024 sc1 lds
    s_add_u32 s46, s46, 40960
    s_add_u32 s47, s47, 40960
    s_add_u32 m0, s48, 3840
    s_nop 0
    buffer_load_dwordx4 v90, s[24:27], s46 offen sc1 lds
    buffer_load_dword v91, s[24:27], s47 offen offset:1024 sc1 lds
    s_add_u32 s46, s46, 204800
    s_add_u32 s47, s47, 204800
    s_add_u32 s48, s48, 10240
    s_add_u32 s49, s49, 1
    s_lshl_b32 s51, s51, 2
    s_branch K_P1Q_RU
K_P1Q_RU_D:
K_P1Q_NOPF:
    s_waitcnt lgkmcnt(4)
    v_mfma_f32_32x32x16_bf16 v[40:55], v[32:35], v[220:223], v[40:55]
    ds_read_b64_tr_b16 v[24:25], v6 offset:36864
    ds_read_b64_tr_b16 v[26:27], v6 offset:37888
    ds_read_b64_tr_b16 v[28:29], v7 offset:36864
    v_mfma_f32_32x32x16_bf16 v[56:71], v[36:39], v[220:223], v[56:71]
    ds_read_b64_tr_b16 v[30:31], v7 offset:37888
    s_waitcnt lgkmcnt(4)
    v_mfma_f32_32x32x16_bf16 v[40:55], v[16:19], v[224:227], v[40:55]
    ds_read_b64_tr_b16 v[32:33], v6 offset:40960
    ds_read_b64_tr_b16 v[34:35], v6 offset:41984
    ds_read_b64_tr_b16 v[36:37], v7 offset:40960
    v_mfma_f32_32x32x16_bf16 v[56:71], v[20:23], v[224:227], v[56:71]
    ds_read_b64_tr_b16 v[38:39], v7 offset:41984
    s_waitcnt lgkmcnt(4)
    v_mfma_f32_32x32x16_bf16 v[40:55], v[24:27], v[228:231], v[40:55]
    ds_read_b64_tr_b16 v[16:17], v6 offset:45056
    ds_read_b64_tr_b16 v[18:19], v6 offset:46080
    ds_read_b64_tr_b16 v[20:21], v7 offset:45056
    v_mfma_f32_32x32x16_bf16 v[56:71], v[28:31], v[228:231], v[56:71]
    ds_read_b64_tr_b16 v[22:23], v7 offset:46080
    s_waitcnt lgkmcnt(4)
    v_mfma_f32_32x32x16_bf16 v[40:55], v[32:35], v[232:235], v[40:55]
    ds_read_b64_tr_b16 v[24:25], v6 offset:49152
    ds_read_b64_tr_b16 v[26:27], v6 offset:50176
    ds_read_b64_tr_b16 v[28:29], v7 offset:49152
    v_mfma_f32_32x32x16_bf16 v[56:71], v[36:39], v[232:235], v[56:71]
    ds_read_b64_tr_b16 v[30:31], v7 offset:50176
    s_waitcnt lgkmcnt(4)
    v_mfma_f32_32x32x16_bf16 v[40:55], v[16:19], v[236:239], v[40:55]
    ds_read_b64_tr_b16 v[32:33], v6 offset:53248
    ds_read_b64_tr_b16 v[34:35], v6 offset:54272
    ds_read_b64_tr_b16 v[36:37], v7 offset:53248
    v_mfma_f32_32x32x16_bf16 v[56:71], v[20:23], v[236:239], v[56:71]
    ds_read_b64_tr_b16 v[38:39], v7 offset:54272
    s_waitcnt lgkmcnt(4)
    v_mfma_f32_32x32x16_bf16 v[40:55], v[24:27], v[240:243], v[40:55]
    ds_read_b64_tr_b16 v[16:17], v6 offset:57344
    ds_read_b64_tr_b16 v[18:19], v6 offset:58368
    ds_read_b64_tr_b16 v[20:21], v7 offset:57344
    v_mfma_f32_32x32x16_bf16 v[56:71], v[28:31], v[240:243], v[56:71]
    ds_read_b64_tr_b16 v[22:23], v7 offset:58368
    s_waitcnt lgkmcnt(4)
    v_mfma_f32_32x32x16_bf16 v[40:55], v[32:35], v[244:247], v[40:55]
    ds_read_b64_tr_b16 v[24:25], v6 offset:61440
    ds_read_b64_tr_b16 v[26:27], v6 offset:62464
    ds_read_b64_tr_b16 v[28:29], v7 offset:61440
    v_mfma_f32_32x32x16_bf16 v[56:71], v[36:39], v[244:247], v[56:71]
    ds_read_b64_tr_b16 v[30:31], v7 offset:62464
    s_waitcnt lgkmcnt(4)
    v_mfma_f32_32x32x16_bf16 v[40:55], v[16:19], v[248:251], v[40:55]
    v_mfma_f32_32x32x16_bf16 v[56:71], v[20:23], v[248:251], v[56:71]
    s_waitcnt lgkmcnt(0)
    v_mfma_f32_32x32x16_bf16 v[40:55], v[24:27], v[252:255], v[40:55]
    v_mfma_f32_32x32x16_bf16 v[56:71], v[28:31], v[252:255], v[56:71]
    s_cmp_lt_u32 s36, 4
    s_cbranch_scc1 K_P1Q_ME
    s_mov_b32 s45, 0
K_P1Q_R1:
    s_cmp_ge_u32 s49, 1
    s_cbranch_scc1 K_P1Q_R1_D
    s_and_b32 s44, s50, s51
    s_cbranch_scc0 K_P1Q_R1_G
    s_mov_b32 s44, 22618112
    buffer_load_dwordx2 v[136:137], v0, s[24:27], s44 offen sc1
    s_waitcnt vmcnt(0)
    v_xor_b32 v136, s10, v136
    v_xor_b32 v137, s11, v137
    v_or_b32 v136, v136, v137
    v_cmp_ne_u32 vcc, 0, v136
    s_add_u32 s45, s45, 1
    s_cmp_gt_u32 s45, 0x40000
    s_cselect_b32 s50, 0, vcc_lo
    s_and_b32 s44, s50, s51
    s_cbranch_scc0 K_P1Q_R1_G
    s_sleep 3
    s_branch K_P1Q_R1
K_P1Q_R1_G:
    s_add_u32 m0, s48, 0
    s_nop 0
    buffer_load_dwordx4 v90, s[24:27], s46 offen sc1 lds
    buffer_load_dword v91, s[24:27], s47 offen offset:1024 sc1 lds
    s_add_u32 s46, s46, 40960
    s_add_u32 s47, s47, 40960
    s_add_u32 m0, s48, 1280
    s_nop 0
    buffer_load_dwordx4 v90, s[24:27], s46 offen sc1 lds
    buffer_load_dword v91, s[24:27], s47 offen offset:1024 sc1 lds
    s_add_u32 s46, s46, 40960
    s_add_u32 s47, s47, 40960
    s_add_u32 m0, s48, 2560
    s_nop 0
    buffer_load_dwordx4 v90, s[24:27], s46 offen sc1 lds
    buffer_load_dword v91, s[24:27], s47 offen offset:1024 sc1 lds
    s_add_u32 s46, s46, 40960
    s_add_u32 s47, s47, 40960
    s_add_u32 m0, s48, 3840
    s_nop 0
    buffer_load_dwordx4 v90, s[24:27], s46 offen sc1 lds
    buffer_load_dword v91, s[24:27], s47 offen offset:1024 sc1 lds
    s_add_u32 s46, s46, 204800
    s_add_u32 s47, s47, 204800
    s_add_u32 s48, s48, 10240
    s_add_u32 s49, s49, 1
    s_lshl_b32 s51, s51, 2
    s_branch K_P1Q_R1
K_P1Q_R1_D:
    s_waitcnt vmcnt(0)
    s_barrier
    s_setprio 1
    s_mov_b32 s45, 0
K_P1Q_R3:
    s_cmp_ge_u32 s49, 3
    s_cbranch_scc1 K_P1Q_R3_D
    s_and_b32 s44, s50, s51
    s_cbranch_scc0 K_P1Q_R3_G
    s_mov_b32 s44, 22618112
    buffer_load_dwordx2 v[136:137], v0, s[24:27], s44 offen sc1
    s_waitcnt vmcnt(0)
    v_xor_b32 v136, s10, v136
    v_xor_b32 v137, s11, v137
    v_or_b32 v136, v136, v137
    v_cmp_ne_u32 vcc, 0, v136
    s_add_u32 s45, s45, 1
    s_cmp_gt_u32 s45, 0x40000
    s_cselect_b32 s50, 0, vcc_lo
    s_and_b32 s44, s50, s51
    s_cbranch_scc0 K_P1Q_R3_G
    s_sleep 3
    s_branch K_P1Q_R3
K_P1Q_R3_G:
    s_add_u32 m0, s48, 0
    s_nop 0
    buffer_load_dwordx4 v90, s[24:27], s46 offen sc1 lds
    buffer_load_dword v91, s[24:27], s47 offen offset:1024 sc1 lds
    s_add_u32 s46, s46, 40960
    s_add_u32 s47, s47, 40960
    s_add_u32 m0, s48, 1280
    s_nop 0
    buffer_load_dwordx4 v90, s[24:27], s46 offen sc1 lds
    buffer_load_dword v91, s[24:27], s47 offen offset:1024 sc1 lds
    s_add_u32 s46, s46, 40960
    s_add_u32 s47, s47, 40960
    s_add_u32 m0, s48, 2560
    s_nop 0
    buffer_load_dwordx4 v90, s[24:27], s46 offen sc1 lds
    buffer_load_dword v91, s[24:27], s47 offen offset:1024 sc1 lds
    s_add_u32 s46, s46, 40960
    s_add_u32 s47, s47, 40960
    s_add_u32 m0, s48, 3840
    s_nop 0
    buffer_load_dwordx4 v90, s[24:27], s46 offen sc1 lds
    buffer_load_dword v91, s[24:27], s47 offen offset:1024 sc1 lds
    s_add_u32 s46, s46, 204800
    s_add_u32 s47, s47, 204800
    s_add_u32 s48, s48, 10240
    s_add_u32 s49, s49, 1
    s_lshl_b32 s51, s51, 2
    s_branch K_P1Q_R3
K_P1Q_R3_D:
K_P1Q_ME:
    s_nop 9
    s_add_u32 s42, s55, 0
    v_pk_mul_f32 v[40:41], v[40:41], s[54:55] op_sel_hi:[1,0]
    v_pk_mul_f32 v[42:43], v[42:43], s[54:55] op_sel_hi:[1,0]
    v_pk_mul_f32 v[44:45], v[44:45], s[54:55] op_sel_hi:[1,0]
    v_pk_mul_f32 v[46:47], v[46:47], s[54:55] op_sel_hi:[1,0]
    v_cvt_pk_bf16_f32 v72, v40, v41
    v_cvt_pk_bf16_f32 v73, v42, v43
    v_cvt_pk_bf16_f32 v74, v44, v45
    v_cvt_pk_bf16_f32 v75, v46, v47
    s_nop 1
    v_permlane32_swap_b32 v72, v74
    v_permlane32_swap_b32 v73, v75
    v_pk_mul_f32 v[48:49], v[48:49], s[54:55] op_sel_hi:[1,0]
    v_pk_mul_f32 v[50:51], v[50:51], s[54:55] op_sel_hi:[1,0]
    v_pk_mul_f32 v[52:53], v[52:53], s[54:55] op_sel_hi:[1,0]
    v_pk_mul_f32 v[54:55], v[54:55], s[54:55] op_sel_hi:[1,0]
    v_cvt_pk_bf16_f32 v76, v48, v49
    v_cvt_pk_bf16_f32 v77, v50, v51
    v_cvt_pk_bf16_f32 v78, v52, v53
    v_cvt_pk_bf16_f32 v79, v54, v55
    s_nop 1
    v_permlane32_swap_b32 v76, v78
    v_permlane32_swap_b32 v77, v79
    v_pk_mul_f32 v[56:57], v[56:57], s[54:55] op_sel_hi:[1,0]
    v_pk_mul_f32 v[58:59], v[58:59], s[54:55] op_sel_hi:[1,0]
    v_pk_mul_f32 v[60:61], v[60:61], s[54:55] op_sel_hi:[1,0]
    v_pk_mul_f32 v[62:63], v[62:63], s[54:55] op_sel_hi:[1,0]
    v_cvt_pk_bf16_f32 v80, v56, v57
    v_cvt_pk_bf16_f32 v81, v58, v59
    v_cvt_pk_bf16_f32 v82, v60, v61
    v_cvt_pk_bf16_f32 v83, v62, v63
    s_nop 1
    v_permlane32_swap_b32 v80, v82
    v_permlane32_swap_b32 v81, v83
    v_pk_mul_f32 v[64:65], v[64:65], s[54:55] op_sel_hi:[1,0]
    v_pk_mul_f32 v[66:67], v[66:67], s[54:55] op_sel_hi:[1,0]
    v_pk_mul_f32 v[68:69], v[68:69], s[54:55] op_sel_hi:[1,0]
    v_pk_mul_f32 v[70:71], v[70:71], s[54:55] op_sel_hi:[1,0]
    v_cvt_pk_bf16_f32 v84, v64, v65
    v_cvt_pk_bf16_f32 v85, v66, v67
    v_cvt_pk_bf16_f32 v86, v68, v69
    v_cvt_pk_bf16_f32 v87, v70, v71
    s_nop 1
    v_permlane32_swap_b32 v84, v86
    v_permlane32_swap_b32 v85, v87
    v_mov_b32 v95, v88
    s_add_u32 s4, s55, 0
    s_add_u32 s5, s55, 1024
    s_add_u32 s6, s55, 2048
    s_add_u32 s7, s55, 3072
    s_branch K_P2
K_P1V:
    s_waitcnt lgkmcnt(5)
    v_mfma_f32_32x32x16_bf16 v[40:55], v[96:99], v[16:19], 0
    ds_read_b64_tr_b16 v[32:33], v6 offset:57344
    ds_read_b64_tr_b16 v[34:35], v6 offset:58368
    ds_read_b128 v[104:107], v74 offset:0
    s_add_u32 m0, s50, 98304
    s_lshl_b32 s46, s48, 7
    s_mul_i32 s47, s48, 245760
    s_add_u32 s48, s48, 1
    s_cmp_eq_u32 s48, 10
    s_cselect_b32 s48, 2, s48
    buffer_load_dwordx4 v2, s[12:15], s46 offen lds
    v_mfma_f32_32x32x16_bf16 v[56:71], v[96:99], v[20:23], 0
    ds_read_b64_tr_b16 v[36:37], v7 offset:57344
    ds_read_b64_tr_b16 v[38:39], v7 offset:58368
    s_waitcnt lgkmcnt(5)
    v_mfma_f32_32x32x16_bf16 v[40:55], v[100:103], v[24:27], v[40:55]
    ds_read_b64_tr_b16 v[16:17], v6 offset:61440
    ds_read_b64_tr_b16 v[18:19], v6 offset:62464
    ds_read_b128 v[108:111], v75 offset:0
    s_add_u32 m0, s50, 99328
    s_nop 0
    buffer_load_dwordx4 v3, s[12:15], s46 offen lds
    v_mfma_f32_32x32x16_bf16 v[56:71], v[100:103], v[28:31], v[56:71]
    ds_read_b64_tr_b16 v[20:21], v7 offset:61440
    ds_read_b64_tr_b16 v[22:23], v7 offset:62464
    s_waitcnt vmcnt(6)
    s_barrier
    s_waitcnt lgkmcnt(5)
    v_mfma_f32_32x32x16_bf16 v[40:55], v[104:107], v[32:35], v[40:55]
    ds_read_b64_tr_b16 v[24:25], v8 offset:0
    ds_read_b64_tr_b16 v[26:27], v8 offset:1024
    ds_read_b128 v[112:115], v76 offset:0
    s_add_u32 m0, s50, 131072
    s_nop 0
    buffer_load_dwordx4 v4, s[16:19], s47 offen lds
    v_mfma_f32_32x32x16_bf16 v[56:71], v[104:107], v[36:39], v[56:71]
    ds_read_b64_tr_b16 v[28:29], v9 offset:0
    ds_read_b64_tr_b16 v[30:31], v9 offset:1024
    s_add_u32 m0, s50, 132096
    s_nop 0
    buffer_load_dwordx4 v5, s[16:19], s47 offen lds
    s_waitcnt lgkmcnt(5)
    v_mfma_f32_32x32x16_bf16 v[40:55], v[108:111], v[16:19], v[40:55]
    ds_read_b64_tr_b16 v[32:33], v8 offset:4096
    ds_read_b64_tr_b16 v[34:35], v8 offset:5120
    ds_read_b128 v[116:119], v77 offset:0
    s_add_u32 m0, s50, 32768
    s_lshl_b32 s46, s48, 7
    s_mul_i32 s47, s48, 245760
    s_add_u32 s48, s48, 1
    s_cmp_eq_u32 s48, 10
    s_cselect_b32 s48, 2, s48
    buffer_load_dwordx4 v2, s[12:15], s46 offen lds
    v_mfma_f32_32x32x16_bf16 v[56:71], v[108:111], v[20:23], v[56:71]
    ds_read_b64_tr_b16 v[36:37], v9 offset:4096
    ds_read_b64_tr_b16 v[38:39], v9 offset:5120
    s_waitcnt lgkmcnt(5)
    v_mfma_f32_32x32x16_bf16 v[40:55], v[112:115], v[24:27], v[40:55]
    ds_read_b64_tr_b16 v[16:17], v8 offset:8192
    ds_read_b64_tr_b16 v[18:19], v8 offset:9216
    ds_read_b128 v[120:123], v78 offset:0
    s_add_u32 m0, s50, 33792
    s_nop 0
    buffer_load_dwordx4 v3, s[12:15], s46 offen lds
    v_mfma_f32_32x32x16_bf16 v[56:71], v[112:115], v[28:31], v[56:71]
    ds_read_b64_tr_b16 v[20:21], v9 offset:8192
    ds_read_b64_tr_b16 v[22:23], v9 offset:9216
    s_waitcnt lgkmcnt(5)
    v_mfma_f32_32x32x16_bf16 v[40:55], v[116:119], v[32:35], v[40:55]
    ds_read_b64_tr_b16 v[24:25], v8 offset:12288
    ds_read_b64_tr_b16 v[26:27], v8 offset:13312
    ds_read_b128 v[124:127], v79 offset:0
    s_add_u32 m0, s50, 147456
    s_nop 0
    buffer_load_dwordx4 v4, s[16:19], s47 offen lds
    v_mfma_f32_32x32x16_bf16 v[56:71], v[116:119], v[36:39], v[56:71]
    ds_read_b64_tr_b16 v[28:29], v9 offset:12288
    ds_read_b64_tr_b16 v[30:31], v9 offset:13312
    s_waitcnt vmcnt(7)
    s_barrier
    s_waitcnt lgkmcnt(5)
    v_mfma_f32_32x32x16_bf16 v[40:55], v[120:123], v[16:19], v[40:55]
    ds_read_b64_tr_b16 v[32:33], v8 offset:49152
    ds_read_b64_tr_b16 v[34:35], v8 offset:50176
    ds_read_b128 v[128:131], v72 offset:16384
    s_add_u32 m0, s50, 148480
    s_nop 0
    buffer_load_dwordx4 v5, s[16:19], s47 offen lds
    v_mfma_f32_32x32x16_bf16 v[56:71], v[120:123], v[20:23], v[56:71]
    ds_read_b64_tr_b16 v[36:37], v9 offset:49152
    ds_read_b64_tr_b16 v[38:39], v9 offset:50176
    s_waitcnt lgkmcnt(5)
    v_mfma_f32_32x32x16_bf16 v[40:55], v[124:127], v[24:27], v[40:55]
    ds_read_b64_tr_b16 v[16:17], v8 offset:53248
    ds_read_b64_tr_b16 v[18:19], v8 offset:54272
    ds_read_b128 v[132:135], v73 offset:16384
    s_add_u32 m0, s50, 0
    s_lshl_b32 s46, s48, 7
    s_mul_i32 s47, s48, 245760
    s_add_u32 s48, s48, 1
    s_cmp_eq_u32 s48, 10
    s_cselect_b32 s48, 2, s48
    buffer_load_dwordx4 v2, s[12:15], s46 offen lds
    v_mfma_f32_32x32x16_bf16 v[56:71], v[124:127], v[28:31], v[56:71]
    ds_read_b64_tr_b16 v[20:21], v9 offset:53248
    ds_read_b64_tr_b16 v[22:23], v9 offset:54272
    s_waitcnt lgkmcnt(5)
    v_mfma_f32_32x32x16_bf16 v[40:55], v[128:131], v[32:35], v[40:55]
    ds_read_b64_tr_b16 v[24:25], v8 offset:57344
    ds_read_b64_tr_b16 v[26:27], v8 offset:58368
    ds_read_b128 v[136:139], v74 offset:16384
    s_add_u32 m0, s50, 1024
    s_nop 0
    buffer_load_dwordx4 v3, s[12:15], s46 offen lds
    v_mfma_f32_32x32x16_bf16 v[56:71], v[128:131], v[36:39], v[56:71]
    ds_read_b64_tr_b16 v[28:29], v9 offset:57344
    ds_read_b64_tr_b16 v[30:31], v9 offset:58368
    s_waitcnt lgkmcnt(5)
    v_mfma_f32_32x32x16_bf16 v[40:55], v[132:135], v[16:19], v[40:55]
    ds_read_b64_tr_b16 v[32:33], v8 offset:61440
    ds_read_b64_tr_b16 v[34:35], v8 offset:62464
    ds_read_b128 v[140:143], v75 offset:16384
    s_add_u32 m0, s50, 49152
    s_nop 0
    buffer_load_dwordx4 v4, s[16:19], s47 offen lds
    v_mfma_f32_32x32x16_bf16 v[56:71], v[132:135], v[20:23], v[56:71]
    ds_read_b64_tr_b16 v[36:37], v9 offset:61440
    ds_read_b64_tr_b16 v[38:39], v9 offset:62464
    s_lshl_b32 s44, s61, 3
    s_add_u32 s44, s44, s36
    s_mul_i32 s44, s44, 1280
    v_mov_b32 v244, 0
    v_mov_b32 v245, 0
    v_mov_b32 v246, 0
    v_mov_b32 v247, 0
    buffer_load_dwordx4 v[240:243], v88, s[12:15], s44 offen
    buffer_load_dwordx4 v[248:251], v88, s[32:35], 0 offen
    buffer_load_dwordx4 v[252:255], v88, s[32:35], 0 offen offset:1024
    s_mov_b64 exec, 0xffff
    buffer_load_dwordx4 v[244:247], v88, s[12:15], s44 offen offset:1024
    s_mov_b64 exec, -1
    s_waitcnt vmcnt(11)
    s_barrier
    s_waitcnt lgkmcnt(5)
    v_mfma_f32_32x32x16_bf16 v[40:55], v[136:139], v[24:27], v[40:55]
    ds_read_b64_tr_b16 v[16:17], v14 offset:0
    ds_read_b64_tr_b16 v[18:19], v14 offset:1024
    ds_read_b128 v[144:147], v76 offset:16384
    s_add_u32 m0, s50, 50176
    s_nop 0
    buffer_load_dwordx4 v5, s[16:19], s47 offen lds
    v_mfma_f32_32x32x16_bf16 v[56:71], v[136:139], v[28:31], v[56:71]
    ds_read_b64_tr_b16 v[20:21], v15 offset:0
    ds_read_b64_tr_b16 v[22:23], v15 offset:1024
    s_waitcnt lgkmcnt(5)
    v_mfma_f32_32x32x16_bf16 v[40:55], v[140:143], v[32:35], v[40:55]
    ds_read_b64_tr_b16 v[24:25], v14 offset:4096
    ds_read_b64_tr_b16 v[26:27], v14 offset:5120
    ds_read_b128 v[148:151], v77 offset:16384
    s_add_u32 m0, s50, 81920
    s_lshl_b32 s46, s48, 7
    s_mul_i32 s47, s48, 245760
    s_add_u32 s48, s48, 1
    s_cmp_eq_u32 s48, 10
    s_cselect_b32 s48, 2, s48
    buffer_load_dwordx4 v2, s[12:15], s46 offen lds
    v_mfma_f32_32x32x16_bf16 v[56:71], v[140:143], v[36:39], v[56:71]
    ds_read_b64_tr_b16 v[28:29], v15 offset:4096
    ds_read_b64_tr_b16 v[30:31], v15 offset:5120
    s_waitcnt lgkmcnt(5)
    v_mfma_f32_32x32x16_bf16 v[40:55], v[144:147], v[16:19], v[40:55]
    ds_read_b64_tr_b16 v[32:33], v14 offset:8192
    ds_read_b64_tr_b16 v[34:35], v14 offset:9216
    ds_read_b128 v[152:155], v78 offset:16384
    s_add_u32 m0, s50, 82944
    s_nop 0
    buffer_load_dwordx4 v3, s[12:15], s46 offen lds
    v_mfma_f32_32x32x16_bf16 v[56:71], v[144:147], v[20:23], v[56:71]
    ds_read_b64_tr_b16 v[36:37], v15 offset:8192
    ds_read_b64_tr_b16 v[38:39], v15 offset:9216
    s_waitcnt lgkmcnt(5)
    v_mfma_f32_32x32x16_bf16 v[40:55], v[148:151], v[24:27], v[40:55]
    ds_read_b64_tr_b16 v[16:17], v14 offset:12288
    ds_read_b64_tr_b16 v[18:19], v14 offset:13312
    ds_read_b128 v[156:159], v79 offset:16384
    s_add_u32 m0, s50, 65536
    s_nop 0
    buffer_load_dwordx4 v4, s[16:19], s47 offen lds
    v_mfma_f32_32x32x16_bf16 v[56:71], v[148:151], v[28:31], v[56:71]
    ds_read_b64_tr_b16 v[20:21], v15 offset:12288
    ds_read_b64_tr_b16 v[22:23], v15 offset:13312
    s_waitcnt vmcnt(11)
    s_barrier
    s_waitcnt lgkmcnt(5)
    v_mfma_f32_32x32x16_bf16 v[40:55], v[152:155], v[32:35], v[40:55]
    ds_read_b64_tr_b16 v[24:25], v14 offset:16384
    ds_read_b64_tr_b16 v[26:27], v14 offset:17408
    ds_read_b128 v[160:163], v72 offset:32768
    s_add_u32 m0, s50, 66560
    s_nop 0
    buffer_load_dwordx4 v5, s[16:19], s47 offen lds
    v_mfma_f32_32x32x16_bf16 v[56:71], v[152:155], v[36:39], v[56:71]
    ds_read_b64_tr_b16 v[28:29], v15 offset:16384
    ds_read_b64_tr_b16 v[30:31], v15 offset:17408
    s_waitcnt lgkmcnt(5)
    v_mfma_f32_32x32x16_bf16 v[40:55], v[156:159], v[16:19], v[40:55]
    ds_read_b64_tr_b16 v[32:33], v14 offset:20480
    ds_read_b64_tr_b16 v[34:35], v14 offset:21504
    ds_read_b128 v[164:167], v73 offset:32768
    s_add_u32 m0, s50, 16384
    s_lshl_b32 s46, s48, 7
    s_mul_i32 s47, s48, 245760
    s_add_u32 s48, s48, 1
    s_cmp_eq_u32 s48, 10
    s_cselect_b32 s48, 2, s48
    buffer_load_dwordx4 v2, s[12:15], s46 offen lds
    v_mfma_f32_32x32x16_bf16 v[56:71], v[156:159], v[20:23], v[56:71]
    ds_read_b64_tr_b16 v[36:37], v15 offset:20480
    ds_read_b64_tr_b16 v[38:39], v15 offset:21504
    s_waitcnt lgkmcnt(5)
    v_mfma_f32_32x32x16_bf16 v[40:55], v[160:163], v[24:27], v[40:55]
    ds_read_b64_tr_b16 v[16:17], v14 offset:24576
    ds_read_b64_tr_b16 v[18:19], v14 offset:25600
    ds_read_b128 v[168:171], v74 offset:32768
    s_add_u32 m0, s50, 17408
    s_nop 0
    buffer_load_dwordx4 v3, s[12:15], s46 offen lds
    v_mfma_f32_32x32x16_bf16 v[56:71], v[160:163], v[28:31], v[56:71]
    ds_read_b64_tr_b16 v[20:21], v15 offset:24576
    ds_read_b64_tr_b16 v[22:23], v15 offset:25600
    s_waitcnt lgkmcnt(5)
    v_mfma_f32_32x32x16_bf16 v[40:55], v[164:167], v[32:35], v[40:55]
    ds_read_b64_tr_b16 v[24:25], v14 offset:28672
    ds_read_b64_tr_b16 v[26:27], v14 offset:29696
    ds_read_b128 v[172:175], v75 offset:32768
    s_add_u32 m0, s50, 114688
    s_nop 0
    buffer_load_dwordx4 v4, s[16:19], s47 offen lds
    v_mfma_f32_32x32x16_bf16 v[56:71], v[164:167], v[36:39], v[56:71]
    ds_read_b64_tr_b16 v[28:29], v15 offset:28672
    ds_read_b64_tr_b16 v[30:31], v15 offset:29696
    v_lshlrev_b32 v80, 3, v1
    v_add_u32 v80, s36, v80
    v_lshrrev_b32 v81, 1, v80
    s_and_b32 s45, s37, 7
    v_lshlrev_b32 v81, 3, v81
    v_add_u32 v81, s45, v81
    v_mul_u32_u24 v81, 3840, v81
    v_and_b32 v80, 1, v80
    v_lshl_add_u32 v81, v80, 7, v81
    s_lshl_b32 s45, s38, 8
    buffer_load_dword v80, v81, s[20:23], s45 offen
    s_waitcnt vmcnt(8)
    s_barrier
    s_waitcnt lgkmcnt(5)
    v_mfma_f32_32x32x16_bf16 v[40:55], v[168:171], v[16:19], v[40:55]
    ds_read_b64_tr_b16 v[32:33], v6 offset:49152
    ds_read_b64_tr_b16 v[34:35], v6 offset:50176
    ds_read_b128 v[176:179], v72 offset:0
    s_add_u32 m0, s50, 115712
    s_nop 0
    buffer_load_dwordx4 v5, s[16:19], s47 offen lds
    v_mfma_f32_32x32x16_bf16 v[56:71], v[168:171], v[20:23], v[56:71]
    ds_read_b64_tr_b16 v[36:37], v7 offset:49152
    ds_read_b64_tr_b16 v[38:39], v7 offset:50176
    s_waitcnt lgkmcnt(5)
    v_mfma_f32_32x32x16_bf16 v[40:55], v[172:175], v[24:27], v[40:55]
    ds_read_b64_tr_b16 v[16:17], v6 offset:53248
    ds_read_b64_tr_b16 v[18:19], v6 offset:54272
    ds_read_b128 v[180:183], v73 offset:0
    s_add_u32 m0, s50, 98304
    s_lshl_b32 s46, s48, 7
    s_mul_i32 s47, s48, 245760
    s_add_u32 s48, s48, 1
    s_cmp_eq_u32 s48, 10
    s_cselect_b32 s48, 2, s48
    buffer_load_dwordx4 v2, s[12:15], s46 offen lds
    v_mfma_f32_32x32x16_bf16 v[56:71], v[172:175], v[28:31], v[56:71]
    ds_read_b64_tr_b16 v[20:21], v7 offset:53248
    ds_read_b64_tr_b16 v[22:23], v7 offset:54272
    s_waitcnt lgkmcnt(5)
    v_mfma_f32_32x32x16_bf16 v[40:55], v[176:179], v[32:35], v[40:55]
    ds_read_b64_tr_b16 v[24:25], v6 offset:57344
    ds_read_b64_tr_b16 v[26:27], v6 offset:58368
    ds_read_b128 v[184:187], v74 offset:0
    s_add_u32 m0, s50, 99328
    s_nop 0
    buffer_load_dwordx4 v3, s[12:15], s46 offen lds
    v_mfma_f32_32x32x16_bf16 v[56:71], v[176:179], v[36:39], v[56:71]
    ds_read_b64_tr_b16 v[28:29], v7 offset:57344
    ds_read_b64_tr_b16 v[30:31], v7 offset:58368
    s_waitcnt lgkmcnt(5)
    v_mfma_f32_32x32x16_bf16 v[40:55], v[180:183], v[16:19], v[40:55]
    ds_read_b64_tr_b16 v[32:33], v6 offset:61440
    ds_read_b64_tr_b16 v[34:35], v6 offset:62464
    ds_read_b128 v[188:191], v75 offset:0
    s_add_u32 m0, s50, 131072
    s_nop 0
    buffer_load_dwordx4 v4, s[16:19], s47 offen lds
    v_mfma_f32_32x32x16_bf16 v[56:71], v[180:183], v[20:23], v[56:71]
    ds_read_b64_tr_b16 v[36:37], v7 offset:61440
    ds_read_b64_tr_b16 v[38:39], v7 offset:62464
    s_waitcnt vmcnt(8)
    s_barrier
    s_waitcnt lgkmcnt(5)
    v_mfma_f32_32x32x16_bf16 v[40:55], v[184:187], v[24:27], v[40:55]
    ds_read_b64_tr_b16 v[16:17], v8 offset:0
    ds_read_b64_tr_b16 v[18:19], v8 offset:1024
    ds_read_b128 v[192:195], v76 offset:0
    s_add_u32 m0, s50, 132096
    s_nop 0
    buffer_load_dwordx4 v5, s[16:19], s47 offen lds
    v_mfma_f32_32x32x16_bf16 v[56:71], v[184:187], v[28:31], v[56:71]
    ds_read_b64_tr_b16 v[20:21], v9 offset:0
    ds_read_b64_tr_b16 v[22:23], v9 offset:1024
    s_waitcnt lgkmcnt(5)
    v_mfma_f32_32x32x16_bf16 v[40:55], v[188:191], v[32:35], v[40:55]
    ds_read_b64_tr_b16 v[24:25], v8 offset:4096
    ds_read_b64_tr_b16 v[26:27], v8 offset:5120
    ds_read_b128 v[196:199], v77 offset:0
    s_add_u32 m0, s50, 32768
    s_lshl_b32 s46, s48, 7
    s_mul_i32 s47, s48, 245760
    s_add_u32 s48, s48, 1
    s_cmp_eq_u32 s48, 10
    s_cselect_b32 s48, 2, s48
    buffer_load_dwordx4 v2, s[12:15], s46 offen lds
    v_mfma_f32_32x32x16_bf16 v[56:71], v[188:191], v[36:39], v[56:71]
    ds_read_b64_tr_b16 v[28:29], v9 offset:4096
    ds_read_b64_tr_b16 v[30:31], v9 offset:5120
    s_waitcnt lgkmcnt(5)
    v_mfma_f32_32x32x16_bf16 v[40:55], v[192:195], v[16:19], v[40:55]
    ds_read_b64_tr_b16 v[32:33], v8 offset:8192
    ds_read_b64_tr_b16 v[34:35], v8 offset:9216
    ds_read_b128 v[200:203], v78 offset:0
    s_add_u32 m0, s50, 33792
    s_nop 0
    buffer_load_dwordx4 v3, s[12:15], s46 offen lds
    v_mfma_f32_32x32x16_bf16 v[56:71], v[192:195], v[20:23], v[56:71]
    ds_read_b64_tr_b16 v[36:37], v9 offset:8192
    ds_read_b64_tr_b16 v[38:39], v9 offset:9216
    s_waitcnt vmcnt(16)
    v_mov_b32 v11, 0
    v_dot2_f32_bf16 v11, v240, v248, v11
    v_dot2_f32_bf16 v11, v241, v249, v11
    v_dot2_f32_bf16 v11, v242, v250, v11
    v_dot2_f32_bf16 v11, v243, v251, v11
    v_dot2_f32_bf16 v11, v244, v252, v11
    v_dot2_f32_bf16 v11, v245, v253, v11
    v_dot2_f32_bf16 v11, v246, v254, v11
    v_dot2_f32_bf16 v11, v247, v255, v11
    s_nop 3
    s_waitcnt lgkmcnt(5)
    v_mfma_f32_32x32x16_bf16 v[40:55], v[196:199], v[24:27], v[40:55]
    ds_read_b64_tr_b16 v[16:17], v8 offset:12288
    ds_read_b64_tr_b16 v[18:19], v8 offset:13312
    ds_read_b128 v[204:207], v79 offset:0
    s_add_u32 m0, s50, 147456
    s_nop 0
    buffer_load_dwordx4 v4, s[16:19], s47 offen lds
    v_mfma_f32_32x32x16_bf16 v[56:71], v[196:199], v[28:31], v[56:71]
    ds_read_b64_tr_b16 v[20:21], v9 offset:12288
    ds_read_b64_tr_b16 v[22:23], v9 offset:13312
    v_add_f32_dpp v11, v11, v11 row_ror:8 row_mask:0xf bank_mask:0xf
    s_nop 1
    v_add_f32_dpp v11, v11, v11 row_ror:4 row_mask:0xf bank_mask:0xf
    s_nop 1
    v_add_f32_dpp v11, v11, v11 row_ror:2 row_mask:0xf bank_mask:0xf
    s_nop 1
    v_add_f32_dpp v11, v11, v11 row_ror:1 row_mask:0xf bank_mask:0xf
    s_nop 1
    s_waitcnt vmcnt(7)
    s_barrier
    s_waitcnt lgkmcnt(5)
    v_mfma_f32_32x32x16_bf16 v[40:55], v[200:203], v[32:35], v[40:55]
    ds_read_b64_tr_b16 v[24:25], v8 offset:49152
    ds_read_b64_tr_b16 v[26:27], v8 offset:50176
    ds_read_b128 v[208:211], v72 offset:16384
    s_add_u32 m0, s50, 148480
    s_nop 0
    buffer_load_dwordx4 v5, s[16:19], s47 offen lds
    v_mfma_f32_32x32x16_bf16 v[56:71], v[200:203], v[36:39], v[56:71]
    ds_read_b64_tr_b16 v[28:29], v9 offset:49152
    ds_read_b64_tr_b16 v[30:31], v9 offset:50176
    s_waitcnt lgkmcnt(5)
    v_mfma_f32_32x32x16_bf16 v[40:55], v[204:207], v[16:19], v[40:55]
    ds_read_b64_tr_b16 v[32:33], v8 offset:53248
    ds_read_b64_tr_b16 v[34:35], v8 offset:54272
    ds_read_b128 v[212:215], v73 offset:16384
    s_add_u32 m0, s50, 49152
    s_mov_b32 s46, 0
    s_mov_b32 s47, 0
    buffer_load_dwordx4 v4, s[20:23], s47 offen lds
    v_mfma_f32_32x32x16_bf16 v[56:71], v[204:207], v[20:23], v[56:71]
    ds_read_b64_tr_b16 v[36:37], v9 offset:53248
    ds_read_b64_tr_b16 v[38:39], v9 offset:54272
    v_readlane_b32 s41, v11, 16
    v_readlane_b32 s42, v11, 32
    v_readlane_b32 s43, v11, 48
    s_nop 1
    v_add_f32 v11, s41, v11
    v_add_f32 v11, s42, v11
    v_add_f32 v11, s43, v11
    v_mul_f32 v11, 0xbfb8aa3b, v11
    v_exp_f32 v11, v11
    s_lshl_b32 s44, s61, 3
    v_add_f32 v11, 1.0, v11
    v_rcp_f32 v11, v11
    s_waitcnt lgkmcnt(5)
    v_mfma_f32_32x32x16_bf16 v[40:55], v[208:211], v[24:27], v[40:55]
    ds_read_b64_tr_b16 v[16:17], v8 offset:57344
    ds_read_b64_tr_b16 v[18:19], v8 offset:58368
    ds_read_b128 v[216:219], v74 offset:16384
    s_add_u32 m0, s50, 50176
    s_nop 0
    buffer_load_dwordx4 v5, s[20:23], s47 offen lds
    v_mfma_f32_32x32x16_bf16 v[56:71], v[208:211], v[28:31], v[56:71]
    ds_read_b64_tr_b16 v[20:21], v9 offset:57344
    ds_read_b64_tr_b16 v[22:23], v9 offset:58368
    s_add_u32 s44, s44, s36
    s_lshl_b32 s44, s44, 2
    s_add_u32 s44, s44, 22609920
    v_mov_b32 v12, 0
    s_mov_b64 exec, 1
    buffer_store_dword v11, v12, s[24:27], s44 offen sc1
    s_mov_b64 exec, -1
    s_waitcnt lgkmcnt(5)
    v_mfma_f32_32x32x16_bf16 v[40:55], v[212:215], v[32:35], v[40:55]
    ds_read_b64_tr_b16 v[24:25], v8 offset:61440
    ds_read_b64_tr_b16 v[26:27], v8 offset:62464
    ds_read_b128 v[220:223], v75 offset:16384
    v_mfma_f32_32x32x16_bf16 v[56:71], v[212:215], v[36:39], v[56:71]
    ds_read_b64_tr_b16 v[28:29], v9 offset:61440
    ds_read_b64_tr_b16 v[30:31], v9 offset:62464
    buffer_load_dwordx2 v[90:91], v94, s[28:31], 0 offen sc1
    s_waitcnt vmcnt(8)
    s_barrier
    s_waitcnt lgkmcnt(5)
    v_mfma_f32_32x32x16_bf16 v[40:55], v[216:219], v[16:19], v[40:55]
    ds_read_b64_tr_b16 v[32:33], v14 offset:0
    ds_read_b64_tr_b16 v[34:35], v14 offset:1024
    ds_read_b128 v[224:227], v76 offset:16384
    s_add_u32 m0, s50, 65536
    s_mov_b32 s46, 128
    s_mov_b32 s47, 245760
    buffer_load_dwordx4 v4, s[20:23], s47 offen lds
    v_mfma_f32_32x32x16_bf16 v[56:71], v[216:219], v[20:23], v[56:71]
    ds_read_b64_tr_b16 v[36:37], v15 offset:0
    ds_read_b64_tr_b16 v[38:39], v15 offset:1024
    s_waitcnt lgkmcnt(5)
    v_mfma_f32_32x32x16_bf16 v[40:55], v[220:223], v[24:27], v[40:55]
    ds_read_b64_tr_b16 v[16:17], v14 offset:4096
    ds_read_b64_tr_b16 v[18:19], v14 offset:5120
    ds_read_b128 v[228:231], v77 offset:16384
    s_add_u32 m0, s50, 66560
    s_nop 0
    buffer_load_dwordx4 v5, s[20:23], s47 offen lds
    v_mfma_f32_32x32x16_bf16 v[56:71], v[220:223], v[28:31], v[56:71]
    ds_read_b64_tr_b16 v[20:21], v15 offset:4096
    ds_read_b64_tr_b16 v[22:23], v15 offset:5120
    s_waitcnt lgkmcnt(5)
    v_mfma_f32_32x32x16_bf16 v[40:55], v[224:227], v[32:35], v[40:55]
    ds_read_b64_tr_b16 v[24:25], v14 offset:8192
    ds_read_b64_tr_b16 v[26:27], v14 offset:9216
    ds_read_b128 v[232:235], v78 offset:16384
    v_mfma_f32_32x32x16_bf16 v[56:71], v[224:227], v[36:39], v[56:71]
    ds_read_b64_tr_b16 v[28:29], v15 offset:8192
    ds_read_b64_tr_b16 v[30:31], v15 offset:9216
    s_waitcnt lgkmcnt(5)
    v_mfma_f32_32x32x16_bf16 v[40:55], v[228:231], v[16:19], v[40:55]
    ds_read_b64_tr_b16 v[32:33], v14 offset:12288
    ds_read_b64_tr_b16 v[34:35], v14 offset:13312
    ds_read_b128 v[236:239], v79 offset:16384
    v_mfma_f32_32x32x16_bf16 v[56:71], v[228:231], v[20:23], v[56:71]
    ds_read_b64_tr_b16 v[36:37], v15 offset:12288
    ds_read_b64_tr_b16 v[38:39], v15 offset:13312
    s_waitcnt vmcnt(6)
    s_barrier
    s_waitcnt lgkmcnt(5)
    v_mfma_f32_32x32x16_bf16 v[40:55], v[232:235], v[24:27], v[40:55]
    ds_read_b64_tr_b16 v[16:17], v14 offset:16384
    ds_read_b64_tr_b16 v[18:19], v14 offset:17408
    ds_read_b128 v[240:243], v72 offset:32768
    s_add_u32 m0, s50, 114688
    s_mov_b32 s48, s49
    s_lshl_b32 s46, s48, 7
    s_mul_i32 s47, s48, 245760
    s_add_u32 s48, s48, 1
    s_cmp_eq_u32 s48, 10
    s_cselect_b32 s48, 2, s48
    buffer_load_dwordx4 v4, s[20:23], s47 offen lds
    v_mfma_f32_32x32x16_bf16 v[56:71], v[232:235], v[28:31], v[56:71]
    ds_read_b64_tr_b16 v[20:21], v15 offset:16384
    ds_read_b64_tr_b16 v[22:23], v15 offset:17408
    s_waitcnt lgkmcnt(5)
    v_mfma_f32_32x32x16_bf16 v[40:55], v[236:239], v[32:35], v[40:55]
    ds_read_b64_tr_b16 v[24:25], v14 offset:20480
    ds_read_b64_tr_b16 v[26:27], v14 offset:21504
    ds_read_b128 v[244:247], v73 offset:32768
    s_add_u32 m0, s50, 115712
    s_nop 0
    buffer_load_dwordx4 v5, s[20:23], s47 offen lds
    v_mfma_f32_32x32x16_bf16 v[56:71], v[236:239], v[36:39], v[56:71]
    ds_read_b64_tr_b16 v[28:29], v15 offset:20480
    ds_read_b64_tr_b16 v[30:31], v15 offset:21504
    s_waitcnt lgkmcnt(5)
    v_mfma_f32_32x32x16_bf16 v[40:55], v[240:243], v[16:19], v[40:55]
    ds_read_b64_tr_b16 v[32:33], v14 offset:24576
    ds_read_b64_tr_b16 v[34:35], v14 offset:25600
    ds_read_b128 v[248:251], v74 offset:32768
    v_mfma_f32_32x32x16_bf16 v[56:71], v[240:243], v[20:23], v[56:71]
    ds_read_b64_tr_b16 v[36:37], v15 offset:24576
    ds_read_b64_tr_b16 v[38:39], v15 offset:25600
    s_waitcnt lgkmcnt(5)
    v_mfma_f32_32x32x16_bf16 v[40:55], v[244:247], v[24:27], v[40:55]
    ds_read_b64_tr_b16 v[16:17], v14 offset:28672
    ds_read_b64_tr_b16 v[18:19], v14 offset:29696
    ds_read_b128 v[252:255], v75 offset:32768
    v_mfma_f32_32x32x16_bf16 v[56:71], v[244:247], v[28:31], v[56:71]
    ds_read_b64_tr_b16 v[20:21], v15 offset:28672
    ds_read_b64_tr_b16 v[22:23], v15 offset:29696
    s_waitcnt vmcnt(6)
    s_barrier
    s_waitcnt lgkmcnt(5)
    v_mfma_f32_32x32x16_bf16 v[40:55], v[248:251], v[32:35], v[40:55]
    ds_read_b64_tr_b16 v[24:25], v6 offset:49152
    ds_read_b64_tr_b16 v[26:27], v6 offset:50176
    ds_read_b64_tr_b16 v[28:29], v7 offset:49152
    s_add_u32 m0, s50, 131072
    s_lshl_b32 s46, s48, 7
    s_mul_i32 s47, s48, 245760
    s_add_u32 s48, s48, 1
    s_cmp_eq_u32 s48, 10
    s_cselect_b32 s48, 2, s48
    buffer_load_dwordx4 v4, s[20:23], s47 offen lds
    v_mfma_f32_32x32x16_bf16 v[56:71], v[248:251], v[36:39], v[56:71]
    ds_read_b64_tr_b16 v[30:31], v7 offset:50176
    s_waitcnt lgkmcnt(4)
    v_mfma_f32_32x32x16_bf16 v[40:55], v[252:255], v[16:19], v[40:55]
    ds_read_b64_tr_b16 v[32:33], v6 offset:53248
    ds_read_b64_tr_b16 v[34:35], v6 offset:54272
    ds_read_b64_tr_b16 v[36:37], v7 offset:53248
    s_add_u32 m0, s50, 132096
    s_nop 0
    buffer_load_dwordx4 v5, s[20:23], s47 offen lds
    v_mfma_f32_32x32x16_bf16 v[56:71], v[252:255], v[20:23], v[56:71]
    ds_read_b64_tr_b16 v[38:39], v7 offset:54272
    s_nop 11
    s_add_u32 s42, s55, 7864320
    v_cvt_pk_bf16_f32 v72, v40, v41
    v_cvt_pk_bf16_f32 v73, v42, v43
    v_cvt_pk_bf16_f32 v74, v44, v45
    v_cvt_pk_bf16_f32 v75, v46, v47
    buffer_store_dwordx4 v[72:75], v10, s[24:27], s42 offen offset:0 sc1
    s_add_u32 s42, s55, 7884800
    v_cvt_pk_bf16_f32 v76, v48, v49
    v_cvt_pk_bf16_f32 v77, v50, v51
    v_cvt_pk_bf16_f32 v78, v52, v53
    v_cvt_pk_bf16_f32 v79, v54, v55
    buffer_store_dwordx4 v[76:79], v10, s[24:27], s42 offen offset:0 sc1
    s_add_u32 s42, s55, 7864320
    v_cvt_pk_bf16_f32 v80, v56, v57
    v_cvt_pk_bf16_f32 v81, v58, v59
    v_cvt_pk_bf16_f32 v82, v60, v61
    v_cvt_pk_bf16_f32 v83, v62, v63
    buffer_store_dwordx4 v[80:83], v10, s[24:27], s42 offen offset:512 sc1
    s_add_u32 s42, s55, 7884800
    v_cvt_pk_bf16_f32 v84, v64, v65
    v_cvt_pk_bf16_f32 v85, v66, v67
    v_cvt_pk_bf16_f32 v86, v68, v69
    v_cvt_pk_bf16_f32 v87, v70, v71
    buffer_store_dwordx4 v[84:87], v10, s[24:27], s42 offen offset:512 sc1
    s_waitcnt lgkmcnt(4)
    v_mfma_f32_32x32x16_bf16 v[40:55], v[96:99], v[24:27], 0
    ds_read_b64_tr_b16 v[16:17], v6 offset:57344
    ds_read_b64_tr_b16 v[18:19], v6 offset:58368
    ds_read_b64_tr_b16 v[20:21], v7 offset:57344
    v_mfma_f32_32x32x16_bf16 v[56:71], v[96:99], v[28:31], 0
    ds_read_b64_tr_b16 v[22:23], v7 offset:58368
    s_waitcnt lgkmcnt(4)
    v_mfma_f32_32x32x16_bf16 v[40:55], v[100:103], v[32:35], v[40:55]
    ds_read_b64_tr_b16 v[24:25], v6 offset:61440
    ds_read_b64_tr_b16 v[26:27], v6 offset:62464
    ds_read_b64_tr_b16 v[28:29], v7 offset:61440
    v_mfma_f32_32x32x16_bf16 v[56:71], v[100:103], v[36:39], v[56:71]
    ds_read_b64_tr_b16 v[30:31], v7 offset:62464
    s_waitcnt vmcnt(8)
    s_barrier
    s_waitcnt lgkmcnt(4)
    v_mfma_f32_32x32x16_bf16 v[40:55], v[104:107], v[16:19], v[40:55]
    ds_read_b64_tr_b16 v[32:33], v8 offset:0
    ds_read_b64_tr_b16 v[34:35], v8 offset:1024
    ds_read_b64_tr_b16 v[36:37], v9 offset:0
    s_add_u32 m0, s50, 0
    s_lshl_b32 s46, s48, 7
    s_mul_i32 s47, s48, 245760
    s_add_u32 s48, s48, 1
    s_cmp_eq_u32 s48, 10
    s_cselect_b32 s48, 2, s48
    buffer_load_dwordx4 v4, s[20:23], s47 offen lds
    v_mfma_f32_32x32x16_bf16 v[56:71], v[104:107], v[20:23], v[56:71]
    ds_read_b64_tr_b16 v[38:39], v9 offset:1024
    s_waitcnt lgkmcnt(4)
    v_mfma_f32_32x32x16_bf16 v[40:55], v[108:111], v[24:27], v[40:55]
    ds_read_b64_tr_b16 v[16:17], v8 offset:4096
    ds_read_b64_tr_b16 v[18:19], v8 offset:5120
    ds_read_b64_tr_b16 v[20:21], v9 offset:4096
    v_mfma_f32_32x32x16_bf16 v[56:71], v[108:111], v[28:31], v[56:71]
    ds_read_b64_tr_b16 v[22:23], v9 offset:5120
    s_waitcnt lgkmcnt(4)
    v_mfma_f32_32x32x16_bf16 v[40:55], v[112:115], v[32:35], v[40:55]
    ds_read_b64_tr_b16 v[24:25], v8 offset:8192
    ds_read_b64_tr_b16 v[26:27], v8 offset:9216
    ds_read_b64_tr_b16 v[28:29], v9 offset:8192
    s_add_u32 m0, s50, 1024
    s_nop 0
    buffer_load_dwordx4 v5, s[20:23], s47 offen lds
    v_mfma_f32_32x32x16_bf16 v[56:71], v[112:115], v[36:39], v[56:71]
    ds_read_b64_tr_b16 v[30:31], v9 offset:9216
    s_waitcnt lgkmcnt(4)
    v_mfma_f32_32x32x16_bf16 v[40:55], v[116:119], v[16:19], v[40:55]
    ds_read_b64_tr_b16 v[32:33], v8 offset:12288
    ds_read_b64_tr_b16 v[34:35], v8 offset:13312
    ds_read_b64_tr_b16 v[36:37], v9 offset:12288
    v_mfma_f32_32x32x16_bf16 v[56:71], v[116:119], v[20:23], v[56:71]
    ds_read_b64_tr_b16 v[38:39], v9 offset:13312
    s_waitcnt vmcnt(8)
    s_barrier
    s_waitcnt lgkmcnt(4)
    v_mfma_f32_32x32x16_bf16 v[40:55], v[120:123], v[24:27], v[40:55]
    ds_read_b64_tr_b16 v[16:17], v8 offset:49152
    ds_read_b64_tr_b16 v[18:19], v8 offset:50176
    ds_read_b64_tr_b16 v[20:21], v9 offset:49152
    s_add_u32 m0, s50, 81920
    s_lshl_b32 s46, s48, 7
    s_mul_i32 s47, s48, 245760
    s_add_u32 s48, s48, 1
    s_cmp_eq_u32 s48, 10
    s_cselect_b32 s48, 2, s48
    buffer_load_dwordx4 v4, s[20:23], s47 offen lds
    v_mfma_f32_32x32x16_bf16 v[56:71], v[120:123], v[28:31], v[56:71]
    ds_read_b64_tr_b16 v[22:23], v9 offset:50176
    s_waitcnt lgkmcnt(4)
    v_mfma_f32_32x32x16_bf16 v[40:55], v[124:127], v[32:35], v[40:55]
    ds_read_b64_tr_b16 v[24:25], v8 offset:53248
    ds_read_b64_tr_b16 v[26:27], v8 offset:54272
    ds_read_b64_tr_b16 v[28:29], v9 offset:53248
    v_mfma_f32_32x32x16_bf16 v[56:71], v[124:127], v[36:39], v[56:71]
    ds_read_b64_tr_b16 v[30:31], v9 offset:54272
    s_waitcnt lgkmcnt(4)
    v_mfma_f32_32x32x16_bf16 v[40:55], v[128:131], v[16:19], v[40:55]
    ds_read_b64_tr_b16 v[32:33], v8 offset:57344
    ds_read_b64_tr_b16 v[34:35], v8 offset:58368
    ds_read_b64_tr_b16 v[36:37], v9 offset:57344
    s_add_u32 m0, s50, 82944
    s_nop 0
    buffer_load_dwordx4 v5, s[20:23], s47 offen lds
    v_mfma_f32_32x32x16_bf16 v[56:71], v[128:131], v[20:23], v[56:71]
    ds_read_b64_tr_b16 v[38:39], v9 offset:58368
    s_waitcnt lgkmcnt(4)
    v_mfma_f32_32x32x16_bf16 v[40:55], v[132:135], v[24:27], v[40:55]
    ds_read_b64_tr_b16 v[16:17], v8 offset:61440
    ds_read_b64_tr_b16 v[18:19], v8 offset:62464
    ds_read_b64_tr_b16 v[20:21], v9 offset:61440
    v_mfma_f32_32x32x16_bf16 v[56:71], v[132:135], v[28:31], v[56:71]
    ds_read_b64_tr_b16 v[22:23], v9 offset:62464
    s_waitcnt vmcnt(8)
    s_barrier
    s_waitcnt lgkmcnt(4)
    v_mfma_f32_32x32x16_bf16 v[40:55], v[136:139], v[32:35], v[40:55]
    ds_read_b64_tr_b16 v[24:25], v14 offset:0
    ds_read_b64_tr_b16 v[26:27], v14 offset:1024
    ds_read_b64_tr_b16 v[28:29], v15 offset:0
    s_add_u32 m0, s50, 16384
    s_lshl_b32 s46, s48, 7
    s_mul_i32 s47, s48, 245760
    s_add_u32 s48, s48, 1
    s_cmp_eq_u32 s48, 10
    s_cselect_b32 s48, 2, s48
    buffer_load_dwordx4 v4, s[20:23], s47 offen lds
    v_mfma_f32_32x32x16_bf16 v[56:71], v[136:139], v[36:39], v[56:71]
    ds_read_b64_tr_b16 v[30:31], v15 offset:1024
    s_waitcnt lgkmcnt(4)
    v_mfma_f32_32x32x16_bf16 v[40:55], v[140:143], v[16:19], v[40:55]
    ds_read_b64_tr_b16 v[32:33], v14 offset:4096
    ds_read_b64_tr_b16 v[34:35], v14 offset:5120
    ds_read_b64_tr_b16 v[36:37], v15 offset:4096
    v_mfma_f32_32x32x16_bf16 v[56:71], v[140:143], v[20:23], v[56:71]
    ds_read_b64_tr_b16 v[38:39], v15 offset:5120
    s_waitcnt lgkmcnt(4)
    v_mfma_f32_32x32x16_bf16 v[40:55], v[144:147], v[24:27], v[40:55]
    ds_read_b64_tr_b16 v[16:17], v14 offset:8192
    ds_read_b64_tr_b16 v[18:19], v14 offset:9216
    ds_read_b64_tr_b16 v[20:21], v15 offset:8192
    s_add_u32 m0, s50, 17408
    s_nop 0
    buffer_load_dwordx4 v5, s[20:23], s47 offen lds
    v_mfma_f32_32x32x16_bf16 v[56:71], v[144:147], v[28:31], v[56:71]
    ds_read_b64_tr_b16 v[22:23], v15 offset:9216
    s_waitcnt lgkmcnt(4)
    v_mfma_f32_32x32x16_bf16 v[40:55], v[148:151], v[32:35], v[40:55]
    ds_read_b64_tr_b16 v[24:25], v14 offset:12288
    ds_read_b64_tr_b16 v[26:27], v14 offset:13312
    ds_read_b64_tr_b16 v[28:29], v15 offset:12288
    v_mfma_f32_32x32x16_bf16 v[56:71], v[148:151], v[36:39], v[56:71]
    ds_read_b64_tr_b16 v[30:31], v15 offset:13312
    s_waitcnt vmcnt(4)
    s_barrier
    s_mov_b32 s45, 0
    s_branch K_P1V_NG_C
K_P1V_NG:
    s_sleep 2
    buffer_load_dwordx2 v[90:91], v94, s[28:31], 0 offen sc1
    s_waitcnt vmcnt(0)
K_P1V_NG_C:
    v_readfirstlane_b32 s10, v90
    v_readfirstlane_b32 s11, v91
    s_add_u32 s45, s45, 1
    s_cmp_gt_u32 s45, 0x40000
    s_cbranch_scc1 K_P1V_NG_D
    s_min_u32 s44, s10, s11
    s_cmp_eq_u32 s44, 0
    s_cbranch_scc1 K_P1V_NG
K_P1V_NG_D:
    s_cmp_lg_u32 s36, 0
    s_cbranch_scc1 K_P1V_F1
    v_mov_b32 v90, s10
    v_mov_b32 v91, s11
    s_lshl_b32 s45, s61, 7
    s_add_u32 s45, s45, 22618112
    s_mov_b64 exec, 1
    buffer_store_dwordx2 v[90:91], v94, s[24:27], s45 offen sc1
    s_mov_b64 exec, -1
K_P1V_F1:
    s_waitcnt lgkmcnt(4)
    v_mfma_f32_32x32x16_bf16 v[40:55], v[152:155], v[16:19], v[40:55]
    ds_read_b64_tr_b16 v[32:33], v6 offset:0
    ds_read_b64_tr_b16 v[34:35], v6 offset:1024
    ds_read_b64_tr_b16 v[36:37], v7 offset:0
    s_add_u32 m0, s50, 147456
    s_lshl_b32 s46, s48, 7
    s_mul_i32 s47, s48, 245760
    s_add_u32 s48, s48, 1
    s_cmp_eq_u32 s48, 10
    s_cselect_b32 s48, 2, s48
    buffer_load_dwordx4 v4, s[20:23], s47 offen lds
    v_mfma_f32_32x32x16_bf16 v[56:71], v[152:155], v[20:23], v[56:71]
    ds_read_b64_tr_b16 v[38:39], v7 offset:1024
    s_waitcnt lgkmcnt(4)
    v_mfma_f32_32x32x16_bf16 v[40:55], v[156:159], v[24:27], v[40:55]
    ds_read_b64_tr_b16 v[16:17], v6 offset:4096
    ds_read_b64_tr_b16 v[18:19], v6 offset:5120
    ds_read_b64_tr_b16 v[20:21], v7 offset:4096
    v_mfma_f32_32x32x16_bf16 v[56:71], v[156:159], v[28:31], v[56:71]
    ds_read_b64_tr_b16 v[22:23], v7 offset:5120
    s_waitcnt lgkmcnt(4)
    v_mfma_f32_32x32x16_bf16 v[40:55], v[160:163], v[32:35], v[40:55]
    ds_read_b64_tr_b16 v[24:25], v6 offset:8192
    ds_read_b64_tr_b16 v[26:27], v6 offset:9216
    ds_read_b64_tr_b16 v[28:29], v7 offset:8192
    s_add_u32 m0, s50, 148480
    s_nop 0
    buffer_load_dwordx4 v5, s[20:23], s47 offen lds
    v_mfma_f32_32x32x16_bf16 v[56:71], v[160:163], v[36:39], v[56:71]
    ds_read_b64_tr_b16 v[30:31], v7 offset:9216
    s_waitcnt lgkmcnt(4)
    v_mfma_f32_32x32x16_bf16 v[40:55], v[164:167], v[16:19], v[40:55]
    ds_read_b64_tr_b16 v[32:33], v6 offset:12288
    ds_read_b64_tr_b16 v[34:35], v6 offset:13312
    ds_read_b64_tr_b16 v[36:37], v7 offset:12288
    v_mfma_f32_32x32x16_bf16 v[56:71], v[164:167], v[20:23], v[56:71]
    ds_read_b64_tr_b16 v[38:39], v7 offset:13312
    s_waitcnt vmcnt(4)
    s_barrier
    s_waitcnt lgkmcnt(4)
    v_mfma_f32_32x32x16_bf16 v[40:55], v[168:171], v[24:27], v[40:55]
    ds_read_b64_tr_b16 v[16:17], v8 offset:16384
    ds_read_b64_tr_b16 v[18:19], v8 offset:17408
    ds_read_b64_tr_b16 v[20:21], v9 offset:16384
    s_add_u32 m0, s50, 32768
    s_lshl_b32 s46, s48, 7
    s_mul_i32 s47, s48, 245760
    s_add_u32 s48, s48, 1
    s_cmp_eq_u32 s48, 10
    s_cselect_b32 s48, 2, s48
    buffer_load_dwordx4 v4, s[20:23], s47 offen lds
    v_mfma_f32_32x32x16_bf16 v[56:71], v[168:171], v[28:31], v[56:71]
    ds_read_b64_tr_b16 v[22:23], v9 offset:17408
    s_waitcnt lgkmcnt(4)
    v_mfma_f32_32x32x16_bf16 v[40:55], v[172:175], v[32:35], v[40:55]
    ds_read_b64_tr_b16 v[24:25], v8 offset:20480
    ds_read_b64_tr_b16 v[26:27], v8 offset:21504
    ds_read_b64_tr_b16 v[28:29], v9 offset:20480
    v_mfma_f32_32x32x16_bf16 v[56:71], v[172:175], v[36:39], v[56:71]
    ds_read_b64_tr_b16 v[30:31], v9 offset:21504
    s_waitcnt lgkmcnt(4)
    v_mfma_f32_32x32x16_bf16 v[40:55], v[176:179], v[16:19], v[40:55]
    ds_read_b64_tr_b16 v[32:33], v8 offset:24576
    ds_read_b64_tr_b16 v[34:35], v8 offset:25600
    ds_read_b64_tr_b16 v[36:37], v9 offset:24576
    s_add_u32 m0, s50, 33792
    s_nop 0
    buffer_load_dwordx4 v5, s[20:23], s47 offen lds
    v_mfma_f32_32x32x16_bf16 v[56:71], v[176:179], v[20:23], v[56:71]
    ds_read_b64_tr_b16 v[38:39], v9 offset:25600
    s_waitcnt lgkmcnt(4)
    v_mfma_f32_32x32x16_bf16 v[40:55], v[180:183], v[24:27], v[40:55]
    ds_read_b64_tr_b16 v[16:17], v8 offset:28672
    ds_read_b64_tr_b16 v[18:19], v8 offset:29696
    ds_read_b64_tr_b16 v[20:21], v9 offset:28672
    v_mfma_f32_32x32x16_bf16 v[56:71], v[180:183], v[28:31], v[56:71]
    ds_read_b64_tr_b16 v[22:23], v9 offset:29696
    s_waitcnt vmcnt(4)
    s_barrier
    s_waitcnt lgkmcnt(4)
    v_mfma_f32_32x32x16_bf16 v[40:55], v[184:187], v[32:35], v[40:55]
    ds_read_b64_tr_b16 v[24:25], v6 offset:16384
    ds_read_b64_tr_b16 v[26:27], v6 offset:17408
    ds_read_b64_tr_b16 v[28:29], v7 offset:16384
    s_add_u32 m0, s50, 49152
    s_lshl_b32 s46, s48, 7
    s_mul_i32 s47, s48, 245760
    s_add_u32 s48, s48, 1
    s_cmp_eq_u32 s48, 10
    s_cselect_b32 s48, 2, s48
    buffer_load_dwordx4 v4, s[20:23], s47 offen lds
    v_mfma_f32_32x32x16_bf16 v[56:71], v[184:187], v[36:39], v[56:71]
    ds_read_b64_tr_b16 v[30:31], v7 offset:17408
    s_waitcnt lgkmcnt(4)
    v_mfma_f32_32x32x16_bf16 v[40:55], v[188:191], v[16:19], v[40:55]
    ds_read_b64_tr_b16 v[32:33], v6 offset:20480
    ds_read_b64_tr_b16 v[34:35], v6 offset:21504
    ds_read_b64_tr_b16 v[36:37], v7 offset:20480
    v_mfma_f32_32x32x16_bf16 v[56:71], v[188:191], v[20:23], v[56:71]
    ds_read_b64_tr_b16 v[38:39], v7 offset:21504
    s_waitcnt lgkmcnt(4)
    v_mfma_f32_32x32x16_bf16 v[40:55], v[192:195], v[24:27], v[40:55]
    ds_read_b64_tr_b16 v[16:17], v6 offset:24576
    ds_read_b64_tr_b16 v[18:19], v6 offset:25600
    ds_read_b64_tr_b16 v[20:21], v7 offset:24576
    s_add_u32 m0, s50, 50176
    s_nop 0
    buffer_load_dwordx4 v5, s[20:23], s47 offen lds
    v_mfma_f32_32x32x16_bf16 v[56:71], v[192:195], v[28:31], v[56:71]
    ds_read_b64_tr_b16 v[22:23], v7 offset:25600
    s_waitcnt lgkmcnt(4)
    v_mfma_f32_32x32x16_bf16 v[40:55], v[196:199], v[32:35], v[40:55]
    ds_read_b64_tr_b16 v[24:25], v6 offset:28672
    ds_read_b64_tr_b16 v[26:27], v6 offset:29696
    ds_read_b64_tr_b16 v[28:29], v7 offset:28672
    v_mfma_f32_32x32x16_bf16 v[56:71], v[196:199], v[36:39], v[56:71]
    ds_read_b64_tr_b16 v[30:31], v7 offset:29696
    s_mov_b32 s44, 22618112
    buffer_load_dwordx2 v[136:137], v0, s[24:27], s44 offen sc1
    s_waitcnt vmcnt(4)
    s_barrier
    s_waitcnt lgkmcnt(4)
    v_mfma_f32_32x32x16_bf16 v[40:55], v[200:203], v[16:19], v[40:55]
    ds_read_b64_tr_b16 v[32:33], v14 offset:16384
    ds_read_b64_tr_b16 v[34:35], v14 offset:17408
    ds_read_b64_tr_b16 v[36:37], v15 offset:16384
    v_mfma_f32_32x32x16_bf16 v[56:71], v[200:203], v[20:23], v[56:71]
    ds_read_b64_tr_b16 v[38:39], v15 offset:17408
    s_waitcnt lgkmcnt(4)
    v_mfma_f32_32x32x16_bf16 v[40:55], v[204:207], v[24:27], v[40:55]
    ds_read_b64_tr_b16 v[16:17], v14 offset:20480
    ds_read_b64_tr_b16 v[18:19], v14 offset:21504
    ds_read_b64_tr_b16 v[20:21], v15 offset:20480
    v_mfma_f32_32x32x16_bf16 v[56:71], v[204:207], v[28:31], v[56:71]
    ds_read_b64_tr_b16 v[22:23], v15 offset:21504
    s_waitcnt lgkmcnt(4)
    v_mfma_f32_32x32x16_bf16 v[40:55], v[208:211], v[32:35], v[40:55]
    ds_read_b64_tr_b16 v[24:25], v14 offset:24576
    ds_read_b64_tr_b16 v[26:27], v14 offset:25600
    ds_read_b64_tr_b16 v[28:29], v15 offset:24576
    v_mfma_f32_32x32x16_bf16 v[56:71], v[208:211], v[36:39], v[56:71]
    ds_read_b64_tr_b16 v[30:31], v15 offset:25600
    s_waitcnt lgkmcnt(4)
    v_mfma_f32_32x32x16_bf16 v[40:55], v[212:215], v[16:19], v[40:55]
    ds_read_b64_tr_b16 v[32:33], v14 offset:28672
    ds_read_b64_tr_b16 v[34:35], v14 offset:29696
    ds_read_b64_tr_b16 v[36:37], v15 offset:28672
    v_mfma_f32_32x32x16_bf16 v[56:71], v[212:215], v[20:23], v[56:71]
    ds_read_b64_tr_b16 v[38:39], v15 offset:29696
    s_waitcnt vmcnt(0)
    s_barrier
    s_waitcnt lgkmcnt(4)
    v_mfma_f32_32x32x16_bf16 v[40:55], v[216:219], v[24:27], v[40:55]
    ds_read_b64_tr_b16 v[16:17], v6 offset:32768
    ds_read_b64_tr_b16 v[18:19], v6 offset:33792
    ds_read_b64_tr_b16 v[20:21], v7 offset:32768
    v_mfma_f32_32x32x16_bf16 v[56:71], v[216:219], v[28:31], v[56:71]
    ds_read_b64_tr_b16 v[22:23], v7 offset:33792
    s_mov_b32 s71, 0
    s_cmp_ge_u32 s36, 4
    s_cbranch_scc1 K_P1V_PH
    s_waitcnt vmcnt(0)
    v_xor_b32 v136, s10, v136
    v_xor_b32 v137, s11, v137
    v_or_b32 v136, v136, v137
    v_cmp_ne_u32 vcc, 0, v136
    s_add_u32 s45, s45, 1
    s_cmp_eq_u64 vcc, 0
    s_cbranch_scc0 K_P1V_NOPF
    v_mov_b32 v100, 0
    v_mov_b32 v101, 0
    v_mov_b32 v102, 0
    v_mov_b32 v103, 0
    s_add_u32 s44, s73, 7864320
    buffer_load_dwordx4 v[96:99], v88, s[24:27], s44 offen sc1
    s_add_u32 s45, s44, s60
    s_mov_b32 exec_hi, 0
    buffer_load_dwordx2 v[100:101], v88, s[24:27], s45 offen sc1
    s_mov_b32 exec_hi, -1
    s_add_u32 s44, s73, 7905280
    buffer_load_dwordx4 v[104:107], v88, s[24:27], s44 offen sc1
    s_add_u32 s45, s44, s60
    s_mov_b32 exec_hi, 0
    buffer_load_dwordx2 v[102:103], v88, s[24:27], s45 offen sc1
    s_mov_b32 exec_hi, -1
    s_mov_b32 s71, 1
    s_branch K_P1V_NOPF
K_P1V_PH:
    s_waitcnt vmcnt(0)
    v_xor_b32 v136, s10, v136
    v_xor_b32 v137, s11, v137
    v_or_b32 v136, v136, v137
    v_cmp_ne_u32 vcc, 0, v136
    s_cmp_ge_u32 s36, 6
    s_cbranch_scc1 K_P1V_HS_V
    v_mov_b32 v90, v88
    v_lshrrev_b32 v91, 1, v1
    v_and_b32 v89, 1, v1
    v_lshlrev_b32 v89, 2, v89
    v_lshl_add_u32 v91, v91, 4, v89
    s_add_u32 s46, s59, 10485760
    s_add_u32 s47, s46, s60
    s_sub_u32 s47, s47, 1024
    s_mov_b32 s48, 0
    s_branch K_P1V_HS_G
K_P1V_HS_V:
    v_mul_u32_u24 v91, 13, v1
    v_lshrrev_b32 v91, 8, v91
    v_mul_u32_u24 v89, 20, v91
    v_sub_u32 v89, v1, v89
    v_mul_u32_u24 v91, 10240, v91
    v_lshl_add_u32 v90, v89, 4, v91
    v_lshlrev_b32 v91, 2, v1
    s_mul_i32 s46, s56, 320
    s_add_u32 s46, s46, 13107200
    s_add_u32 s47, s46, 29760
    s_mov_b32 s48, 81920
K_P1V_HS_G:
    s_and_b32 s44, s36, 1
    s_mul_i32 s45, s44, 163840
    s_add_u32 s46, s46, s45
    s_add_u32 s47, s47, s45
    s_mul_i32 s45, s44, 5120
    s_add_u32 s48, s48, s45
    s_lshl_b32 s51, 0x10001, s44
    s_mov_b32 s49, 0
    s_mov_b32 s50, vcc_lo
    s_mov_b32 s45, 0
K_P1V_RU:
    s_cmp_ge_u32 s49, 1
    s_cbranch_scc1 K_P1V_RU_D
    s_and_b32 s44, s50, s51
    s_cbranch_scc0 K_P1V_RU_G
    s_branch K_P1V_RU_D
K_P1V_RU_G:
    s_add_u32 m0, s48, 0
    s_nop 0
    buffer_load_dwordx4 v90, s[24:27], s46 offen sc1 lds
    buffer_load_dword v91, s[24:27], s47 offen offset:1024 sc1 lds
    s_add_u32 s46, s46, 40960
    s_add_u32 s47, s47, 40960
    s_add_u32 m0, s48, 1280
    s_nop 0
    buffer_load_dwordx4 v90, s[24:27], s46 offen sc1 lds
    buffer_load_dword v91, s[24:27], s47 offen offset:1024 sc1 lds
    s_add_u32 s46, s46, 40960
    s_add_u32 s47, s47, 40960
    s_add_u32 m0, s48, 2560
    s_nop 0
    buffer_load_dwordx4 v90, s[24:27], s46 offen sc1 lds
    buffer_load_dword v91, s[24:27], s47 offen offset:1024 sc1 lds
    s_add_u32 s46, s46, 40960
    s_add_u32 s47, s47, 40960
    s_add_u32 m0, s48, 3840
    s_nop 0
    buffer_load_dwordx4 v90, s[24:27], s46 offen sc1 lds
    buffer_load_dword v91, s[24:27], s47 offen offset:1024 sc1 lds
    s_add_u32 s46, s46, 204800
    s_add_u32 s47, s47, 204800
    s_add_u32 s48, s48, 10240
    s_add_u32 s49, s49, 1
    s_lshl_b32 s51, s51, 2
    s_branch K_P1V_RU
K_P1V_RU_D:
K_P1V_NOPF:
    s_waitcnt lgkmcnt(4)
    v_mfma_f32_32x32x16_bf16 v[40:55], v[220:223], v[32:35], v[40:55]
    ds_read_b64_tr_b16 v[24:25], v6 offset:36864
    ds_read_b64_tr_b16 v[26:27], v6 offset:37888
    ds_read_b64_tr_b16 v[28:29], v7 offset:36864
    v_mfma_f32_32x32x16_bf16 v[56:71], v[220:223], v[36:39], v[56:71]
    ds_read_b64_tr_b16 v[30:31], v7 offset:37888
    s_waitcnt lgkmcnt(4)
    v_mfma_f32_32x32x16_bf16 v[40:55], v[224:227], v[16:19], v[40:55]
    ds_read_b64_tr_b16 v[32:33], v6 offset:40960
    ds_read_b64_tr_b16 v[34:35], v6 offset:41984
    ds_read_b64_tr_b16 v[36:37], v7 offset:40960
    v_mfma_f32_32x32x16_bf16 v[56:71], v[224:227], v[20:23], v[56:71]
    ds_read_b64_tr_b16 v[38:39], v7 offset:41984
    s_waitcnt lgkmcnt(4)
    v_mfma_f32_32x32x16_bf16 v[40:55], v[228:231], v[24:27], v[40:55]
    ds_read_b64_tr_b16 v[16:17], v6 offset:45056
    ds_read_b64_tr_b16 v[18:19], v6 offset:46080
    ds_read_b64_tr_b16 v[20:21], v7 offset:45056
    v_mfma_f32_32x32x16_bf16 v[56:71], v[228:231], v[28:31], v[56:71]
    ds_read_b64_tr_b16 v[22:23], v7 offset:46080
    s_waitcnt lgkmcnt(4)
    v_mfma_f32_32x32x16_bf16 v[40:55], v[232:235], v[32:35], v[40:55]
    ds_read_b64_tr_b16 v[24:25], v6 offset:49152
    ds_read_b64_tr_b16 v[26:27], v6 offset:50176
    ds_read_b64_tr_b16 v[28:29], v7 offset:49152
    v_mfma_f32_32x32x16_bf16 v[56:71], v[232:235], v[36:39], v[56:71]
    ds_read_b64_tr_b16 v[30:31], v7 offset:50176
    s_waitcnt lgkmcnt(4)
    v_mfma_f32_32x32x16_bf16 v[40:55], v[236:239], v[16:19], v[40:55]
    ds_read_b64_tr_b16 v[32:33], v6 offset:53248
    ds_read_b64_tr_b16 v[34:35], v6 offset:54272
    ds_read_b64_tr_b16 v[36:37], v7 offset:53248
    v_mfma_f32_32x32x16_bf16 v[56:71], v[236:239], v[20:23], v[56:71]
    ds_read_b64_tr_b16 v[38:39], v7 offset:54272
    s_waitcnt lgkmcnt(4)
    v_mfma_f32_32x32x16_bf16 v[40:55], v[240:243], v[24:27], v[40:55]
    ds_read_b64_tr_b16 v[16:17], v6 offset:57344
    ds_read_b64_tr_b16 v[18:19], v6 offset:58368
    ds_read_b64_tr_b16 v[20:21], v7 offset:57344
    v_mfma_f32_32x32x16_bf16 v[56:71], v[240:243], v[28:31], v[56:71]
    ds_read_b64_tr_b16 v[22:23], v7 offset:58368
    s_waitcnt lgkmcnt(4)
    v_mfma_f32_32x32x16_bf16 v[40:55], v[244:247], v[32:35], v[40:55]
    ds_read_b64_tr_b16 v[24:25], v6 offset:61440
    ds_read_b64_tr_b16 v[26:27], v6 offset:62464
    ds_read_b64_tr_b16 v[28:29], v7 offset:61440
    v_mfma_f32_32x32x16_bf16 v[56:71], v[244:247], v[36:39], v[56:71]
    ds_read_b64_tr_b16 v[30:31], v7 offset:62464
    s_waitcnt lgkmcnt(4)
    v_mfma_f32_32x32x16_bf16 v[40:55], v[248:251], v[16:19], v[40:55]
    v_mfma_f32_32x32x16_bf16 v[56:71], v[248:251], v[20:23], v[56:71]
    s_waitcnt lgkmcnt(0)
    v_mfma_f32_32x32x16_bf16 v[40:55], v[252:255], v[24:27], v[40:55]
    v_mfma_f32_32x32x16_bf16 v[56:71], v[252:255], v[28:31], v[56:71]
    s_cmp_lt_u32 s36, 4
    s_cbranch_scc1 K_P1V_ME
    s_mov_b32 s45, 0
K_P1V_R1:
    s_cmp_ge_u32 s49, 1
    s_cbranch_scc1 K_P1V_R1_D
    s_and_b32 s44, s50, s51
    s_cbranch_scc0 K_P1V_R1_G
    s_mov_b32 s44, 22618112
    buffer_load_dwordx2 v[136:137], v0, s[24:27], s44 offen sc1
    s_waitcnt vmcnt(0)
    v_xor_b32 v136, s10, v136
    v_xor_b32 v137, s11, v137
    v_or_b32 v136, v136, v137
    v_cmp_ne_u32 vcc, 0, v136
    s_add_u32 s45, s45, 1
    s_cmp_gt_u32 s45, 0x40000
    s_cselect_b32 s50, 0, vcc_lo
    s_and_b32 s44, s50, s51
    s_cbranch_scc0 K_P1V_R1_G
    s_sleep 3
    s_branch K_P1V_R1
K_P1V_R1_G:
    s_add_u32 m0, s48, 0
    s_nop 0
    buffer_load_dwordx4 v90, s[24:27], s46 offen sc1 lds
    buffer_load_dword v91, s[24:27], s47 offen offset:1024 sc1 lds
    s_add_u32 s46, s46, 40960
    s_add_u32 s47, s47, 40960
    s_add_u32 m0, s48, 1280
    s_nop 0
    buffer_load_dwordx4 v90, s[24:27], s46 offen sc1 lds
    buffer_load_dword v91, s[24:27], s47 offen offset:1024 sc1 lds
    s_add_u32 s46, s46, 40960
    s_add_u32 s47, s47, 40960
    s_add_u32 m0, s48, 2560
    s_nop 0
    buffer_load_dwordx4 v90, s[24:27], s46 offen sc1 lds
    buffer_load_dword v91, s[24:27], s47 offen offset:1024 sc1 lds
    s_add_u32 s46, s46, 40960
    s_add_u32 s47, s47, 40960
    s_add_u32 m0, s48, 3840
    s_nop 0
    buffer_load_dwordx4 v90, s[24:27], s46 offen sc1 lds
    buffer_load_dword v91, s[24:27], s47 offen offset:1024 sc1 lds
    s_add_u32 s46, s46, 204800
    s_add_u32 s47, s47, 204800
    s_add_u32 s48, s48, 10240
    s_add_u32 s49, s49, 1
    s_lshl_b32 s51, s51, 2
    s_branch K_P1V_R1
K_P1V_R1_D:
    s_waitcnt vmcnt(0)
    s_barrier
    s_setprio 1
    s_mov_b32 s45, 0
K_P1V_R3:
    s_cmp_ge_u32 s49, 3
    s_cbranch_scc1 K_P1V_R3_D
    s_and_b32 s44, s50, s51
    s_cbranch_scc0 K_P1V_R3_G
    s_mov_b32 s44, 22618112
    buffer_load_dwordx2 v[136:137], v0, s[24:27], s44 offen sc1
    s_waitcnt vmcnt(0)
    v_xor_b32 v136, s10, v136
    v_xor_b32 v137, s11, v137
    v_or_b32 v136, v136, v137
    v_cmp_ne_u32 vcc, 0, v136
    s_add_u32 s45, s45, 1
    s_cmp_gt_u32 s45, 0x40000
    s_cselect_b32 s50, 0, vcc_lo
    s_and_b32 s44, s50, s51
    s_cbranch_scc0 K_P1V_R3_G
    s_sleep 3
    s_branch K_P1V_R3
K_P1V_R3_G:
    s_add_u32 m0, s48, 0
    s_nop 0
    buffer_load_dwordx4 v90, s[24:27], s46 offen sc1 lds
    buffer_load_dword v91, s[24:27], s47 offen offset:1024 sc1 lds
    s_add_u32 s46, s46, 40960
    s_add_u32 s47, s47, 40960
    s_add_u32 m0, s48, 1280
    s_nop 0
    buffer_load_dwordx4 v90, s[24:27], s46 offen sc1 lds
    buffer_load_dword v91, s[24:27], s47 offen offset:1024 sc1 lds
    s_add_u32 s46, s46, 40960
    s_add_u32 s47, s47, 40960
    s_add_u32 m0, s48, 2560
    s_nop 0
    buffer_load_dwordx4 v90, s[24:27], s46 offen sc1 lds
    buffer_load_dword v91, s[24:27], s47 offen offset:1024 sc1 lds
    s_add_u32 s46, s46, 40960
    s_add_u32 s47, s47, 40960
    s_add_u32 m0, s48, 3840
    s_nop 0
    buffer_load_dwordx4 v90, s[24:27], s46 offen sc1 lds
    buffer_load_dword v91, s[24:27], s47 offen offset:1024 sc1 lds
    s_add_u32 s46, s46, 204800
    s_add_u32 s47, s47, 204800
    s_add_u32 s48, s48, 10240
    s_add_u32 s49, s49, 1
    s_lshl_b32 s51, s51, 2
    s_branch K_P1V_R3
K_P1V_R3_D:
K_P1V_ME:
    s_nop 9
    s_add_u32 s42, s55, 0
    v_cvt_pk_bf16_f32 v72, v40, v41
    v_cvt_pk_bf16_f32 v73, v42, v43
    v_cvt_pk_bf16_f32 v74, v44, v45
    v_cvt_pk_bf16_f32 v75, v46, v47
    s_add_u32 s42, s55, 20480
    v_cvt_pk_bf16_f32 v76, v48, v49
    v_cvt_pk_bf16_f32 v77, v50, v51
    v_cvt_pk_bf16_f32 v78, v52, v53
    v_cvt_pk_bf16_f32 v79, v54, v55
    s_add_u32 s42, s55, 0
    v_cvt_pk_bf16_f32 v80, v56, v57
    v_cvt_pk_bf16_f32 v81, v58, v59
    v_cvt_pk_bf16_f32 v82, v60, v61
    v_cvt_pk_bf16_f32 v83, v62, v63
    s_add_u32 s42, s55, 20480
    v_cvt_pk_bf16_f32 v84, v64, v65
    v_cvt_pk_bf16_f32 v85, v66, v67
    v_cvt_pk_bf16_f32 v86, v68, v69
    v_cvt_pk_bf16_f32 v87, v70, v71
    v_mov_b32 v95, v10
    s_add_u32 s4, s55, 0
    s_add_u32 s5, s55, 20480
    s_add_u32 s6, s55, 512
    s_add_u32 s7, s55, 20992
    s_branch K_P2
K_SPARE:
    s_lshl_b32 s44, s61, 3
    s_add_u32 s44, s44, s36
    s_mul_i32 s44, s44, 1280
    v_mov_b32 v244, 0
    v_mov_b32 v245, 0
    v_mov_b32 v246, 0
    v_mov_b32 v247, 0
    buffer_load_dwordx4 v[240:243], v88, s[12:15], s44 offen
    buffer_load_dwordx4 v[248:251], v88, s[32:35], 0 offen
    buffer_load_dwordx4 v[252:255], v88, s[32:35], 0 offen offset:1024
    s_mov_b64 exec, 0xffff
    buffer_load_dwordx4 v[244:247], v88, s[12:15], s44 offen offset:1024
    s_mov_b64 exec, -1
    s_load_dwordx2 s[4:5], s[0:1], 16
    s_load_dwordx2 s[6:7], s[0:1], 40
    s_sub_u32 s46, s40, 30
    s_mov_b32 s47, s39
    s_memrealtime s[10:11]
    s_waitcnt lgkmcnt(0)
    s_cmp_lg_u32 s2, 240
    s_cbranch_scc1 K_SP1
    s_cmp_lg_u32 s36, 7
    s_cbranch_scc1 K_SP1
    s_or_b32 s41, s10, 1
    s_or_b32 s42, s11, 0x80000000
    v_mov_b32 v90, s41
    v_mov_b32 v91, s42
    s_mov_b64 exec, 1
    buffer_store_dwordx2 v[90:91], v94, s[28:31], 0 offen sc1
    s_mov_b64 exec, -1
K_SP1:
    s_cmp_eq_u32 s46, 0
    s_cselect_b32 s16, s4, s6
    s_cselect_b32 s17, s5, s7
    s_and_b32 s17, s17, 0xffff
    s_mov_b32 s18, 819200
    s_mov_b32 s19, 0x00020000
    v_add_u32 v20, 0, v1
    v_mul_u32_u24 v21, 205, v20
    v_lshrrev_b32 v21, 11, v21
    v_mul_u32_u24 v22, 10, v21
    v_sub_u32 v20, v20, v22
    v_mul_u32_u24 v21, 1280, v21
    v_lshl_add_u32 v24, v20, 4, v21
    v_add_u32 v20, 64, v1
    v_mul_u32_u24 v21, 205, v20
    v_lshrrev_b32 v21, 11, v21
    v_mul_u32_u24 v22, 10, v21
    v_sub_u32 v20, v20, v22
    v_mul_u32_u24 v21, 1280, v21
    v_lshl_add_u32 v25, v20, 4, v21
    v_add_u32 v20, 128, v1
    v_mul_u32_u24 v21, 205, v20
    v_lshrrev_b32 v21, 11, v21
    v_mul_u32_u24 v22, 10, v21
    v_sub_u32 v20, v20, v22
    v_mul_u32_u24 v21, 1280, v21
    v_lshl_add_u32 v26, v20, 4, v21
    v_add_u32 v20, 192, v1
    v_mul_u32_u24 v21, 205, v20
    v_lshrrev_b32 v21, 11, v21
    v_mul_u32_u24 v22, 10, v21
    v_sub_u32 v20, v20, v22
    v_mul_u32_u24 v21, 1280, v21
    v_lshl_add_u32 v27, v20, 4, v21
    v_add_u32 v20, 256, v1
    v_mul_u32_u24 v21, 205, v20
    v_lshrrev_b32 v21, 11, v21
    v_mul_u32_u24 v22, 10, v21
    v_sub_u32 v20, v20, v22
    v_mul_u32_u24 v21, 1280, v21
    v_lshl_add_u32 v28, v20, 4, v21
    s_mul_i32 s41, s47, 160
    s_mul_i32 s42, s36, 40960
    s_add_u32 s41, s41, s42
    s_mul_i32 s42, s36, 5120
    s_add_u32 m0, s42, 0
    s_nop 0
    buffer_load_dwordx4 v24, s[16:19], s41 offen lds
    s_add_u32 m0, s42, 1024
    s_nop 0
    buffer_load_dwordx4 v25, s[16:19], s41 offen lds
    s_add_u32 m0, s42, 2048
    s_nop 0
    buffer_load_dwordx4 v26, s[16:19], s41 offen lds
    s_add_u32 m0, s42, 3072
    s_nop 0
    buffer_load_dwordx4 v27, s[16:19], s41 offen lds
    s_add_u32 m0, s42, 4096
    s_nop 0
    buffer_load_dwordx4 v28, s[16:19], s41 offen lds
    s_add_u32 s41, s41, 327680
    s_add_u32 m0, s42, 40960
    s_nop 0
    buffer_load_dwordx4 v24, s[16:19], s41 offen lds
    s_add_u32 m0, s42, 41984
    s_nop 0
    buffer_load_dwordx4 v25, s[16:19], s41 offen lds
    s_add_u32 m0, s42, 43008
    s_nop 0
    buffer_load_dwordx4 v26, s[16:19], s41 offen lds
    s_add_u32 m0, s42, 44032
    s_nop 0
    buffer_load_dwordx4 v27, s[16:19], s41 offen lds
    s_add_u32 m0, s42, 45056
    s_nop 0
    buffer_load_dwordx4 v28, s[16:19], s41 offen lds
    s_add_u32 s41, s41, 327680
    s_add_u32 m0, s42, 81920
    s_nop 0
    buffer_load_dwordx4 v24, s[16:19], s41 offen lds
    s_add_u32 m0, s42, 82944
    s_nop 0
    buffer_load_dwordx4 v25, s[16:19], s41 offen lds
    s_add_u32 m0, s42, 83968
    s_nop 0
    buffer_load_dwordx4 v26, s[16:19], s41 offen lds
    s_add_u32 m0, s42, 84992
    s_nop 0
    buffer_load_dwordx4 v27, s[16:19], s41 offen lds
    s_add_u32 m0, s42, 86016
    s_nop 0
    buffer_load_dwordx4 v28, s[16:19], s41 offen lds
    s_add_u32 s41, s41, 327680
    v_lshrrev_b32 v20, 4, v1
    s_lshl_b32 s41, s36, 2
    v_add_u32 v20, s41, v20
    v_mul_u32_u24 v21, 13, v20
    v_lshrrev_b32 v21, 6, v21
    v_mul_u32_u24 v22, 5, v21
    v_sub_u32 v22, v20, v22
    v_lshrrev_b32 v23, 1, v22
    v_mul_u32_u24 v23, 20, v23
    v_and_b32 v24, 1, v22
    v_lshl_add_u32 v23, v24, 2, v23
    v_cmp_eq_u32 vcc, 4, v22
    v_mov_b32 v24, 16
    v_mov_b32 v25, 8
    v_mov_b32 v26, 20
    v_cndmask_b32 v23, v23, v24, vcc
    v_cndmask_b32 v25, v25, v26, vcc
    v_mad_u32_u24 v23, v21, 40, v23
    v_bfe_u32 v24, v1, 2, 2
    v_add_u32 v23, v23, v24
    v_add_u32 v25, v23, v25
    v_and_b32 v24, 3, v1
    v_mul_u32_u24 v24, 40, v24
    v_mov_b32 v26, 160
    v_mad_u32_u24 v23, v23, v26, v24
    v_mad_u32_u24 v25, v25, v26, v24
    v_add_u32 v27, 51200, v23
    v_add_u32 v28, 51200, v25
    s_mul_i32 s55, s47, 40
    s_mul_i32 s42, s46, 20
    s_add_u32 s55, s55, s42
    s_add_u32 s55, s55, s36
    s_mul_i32 s55, s55, 5120
    s_add_u32 s55, s55, 20971520
    s_waitcnt vmcnt(0)
    s_barrier
    v_mov_b32 v11, 0
    v_dot2_f32_bf16 v11, v240, v248, v11
    v_dot2_f32_bf16 v11, v241, v249, v11
    v_dot2_f32_bf16 v11, v242, v250, v11
    v_dot2_f32_bf16 v11, v243, v251, v11
    v_dot2_f32_bf16 v11, v244, v252, v11
    v_dot2_f32_bf16 v11, v245, v253, v11
    v_dot2_f32_bf16 v11, v246, v254, v11
    v_dot2_f32_bf16 v11, v247, v255, v11
    s_nop 3
    v_add_f32_dpp v11, v11, v11 row_ror:8 row_mask:0xf bank_mask:0xf
    s_nop 1
    v_add_f32_dpp v11, v11, v11 row_ror:4 row_mask:0xf bank_mask:0xf
    s_nop 1
    v_add_f32_dpp v11, v11, v11 row_ror:2 row_mask:0xf bank_mask:0xf
    s_nop 1
    v_add_f32_dpp v11, v11, v11 row_ror:1 row_mask:0xf bank_mask:0xf
    s_nop 1
    v_readlane_b32 s41, v11, 16
    v_readlane_b32 s42, v11, 32
    v_readlane_b32 s43, v11, 48
    s_nop 1
    v_add_f32 v11, s41, v11
    v_add_f32 v11, s42, v11
    v_add_f32 v11, s43, v11
    v_mul_f32 v11, 0xbfb8aa3b, v11
    v_exp_f32 v11, v11
    s_lshl_b32 s44, s61, 3
    v_add_f32 v11, 1.0, v11
    v_rcp_f32 v11, v11
    s_add_u32 s44, s44, s36
    s_lshl_b32 s44, s44, 2
    s_add_u32 s44, s44, 22609920
    v_mov_b32 v12, 0
    s_mov_b64 exec, 1
    buffer_store_dword v11, v12, s[24:27], s44 offen sc1
    s_mov_b64 exec, -1
    s_cmp_ge_u32 s36, 5
    s_cbranch_scc1 K_SP2
    ds_read_b64_tr_b16 v[32:33], v23 offset:0
    ds_read_b64_tr_b16 v[34:35], v25 offset:0
    ds_read_b64_tr_b16 v[36:37], v23 offset:8
    ds_read_b64_tr_b16 v[38:39], v25 offset:8
    ds_read_b64_tr_b16 v[40:41], v23 offset:16
    ds_read_b64_tr_b16 v[42:43], v25 offset:16
    ds_read_b64_tr_b16 v[44:45], v23 offset:24
    ds_read_b64_tr_b16 v[46:47], v25 offset:24
    ds_read_b64_tr_b16 v[48:49], v23 offset:32
    ds_read_b64_tr_b16 v[50:51], v25 offset:32
    s_add_u32 s42, s55, 4096
    s_waitcnt lgkmcnt(8)
    buffer_store_dwordx4 v[32:35], v88, s[24:27], s55 offen offset:0 sc1
    s_waitcnt lgkmcnt(6)
    buffer_store_dwordx4 v[36:39], v88, s[24:27], s55 offen offset:1024 sc1
    s_waitcnt lgkmcnt(4)
    buffer_store_dwordx4 v[40:43], v88, s[24:27], s55 offen offset:2048 sc1
    s_waitcnt lgkmcnt(2)
    buffer_store_dwordx4 v[44:47], v88, s[24:27], s55 offen offset:3072 sc1
    s_waitcnt lgkmcnt(0)
    buffer_store_dwordx4 v[48:51], v88, s[24:27], s42 offen sc1
    s_add_u32 s55, s55, 25600
    ds_read_b64_tr_b16 v[52:53], v23 offset:25600
    ds_read_b64_tr_b16 v[54:55], v25 offset:25600
    ds_read_b64_tr_b16 v[56:57], v23 offset:25608
    ds_read_b64_tr_b16 v[58:59], v25 offset:25608
    ds_read_b64_tr_b16 v[60:61], v23 offset:25616
    ds_read_b64_tr_b16 v[62:63], v25 offset:25616
    ds_read_b64_tr_b16 v[64:65], v23 offset:25624
    ds_read_b64_tr_b16 v[66:67], v25 offset:25624
    ds_read_b64_tr_b16 v[68:69], v23 offset:25632
    ds_read_b64_tr_b16 v[70:71], v25 offset:25632
    s_add_u32 s42, s55, 4096
    s_waitcnt lgkmcnt(8)
    buffer_store_dwordx4 v[52:55], v88, s[24:27], s55 offen offset:0 sc1
    s_waitcnt lgkmcnt(6)
    buffer_store_dwordx4 v[56:59], v88, s[24:27], s55 offen offset:1024 sc1
    s_waitcnt lgkmcnt(4)
    buffer_store_dwordx4 v[60:63], v88, s[24:27], s55 offen offset:2048 sc1
    s_waitcnt lgkmcnt(2)
    buffer_store_dwordx4 v[64:67], v88, s[24:27], s55 offen offset:3072 sc1
    s_waitcnt lgkmcnt(0)
    buffer_store_dwordx4 v[68:71], v88, s[24:27], s42 offen sc1
    s_add_u32 s55, s55, 25600
    ds_read_b64_tr_b16 v[32:33], v27 offset:0
    ds_read_b64_tr_b16 v[34:35], v28 offset:0
    ds_read_b64_tr_b16 v[36:37], v27 offset:8
    ds_read_b64_tr_b16 v[38:39], v28 offset:8
    ds_read_b64_tr_b16 v[40:41], v27 offset:16
    ds_read_b64_tr_b16 v[42:43], v28 offset:16
    ds_read_b64_tr_b16 v[44:45], v27 offset:24
    ds_read_b64_tr_b16 v[46:47], v28 offset:24
    ds_read_b64_tr_b16 v[48:49], v27 offset:32
    ds_read_b64_tr_b16 v[50:51], v28 offset:32
    s_add_u32 s42, s55, 4096
    s_waitcnt lgkmcnt(8)
    buffer_store_dwordx4 v[32:35], v88, s[24:27], s55 offen offset:0 sc1
    s_waitcnt lgkmcnt(6)
    buffer_store_dwordx4 v[36:39], v88, s[24:27], s55 offen offset:1024 sc1
    s_waitcnt lgkmcnt(4)
    buffer_store_dwordx4 v[40:43], v88, s[24:27], s55 offen offset:2048 sc1
    s_waitcnt lgkmcnt(2)
    buffer_store_dwordx4 v[44:47], v88, s[24:27], s55 offen offset:3072 sc1
    s_waitcnt lgkmcnt(0)
    buffer_store_dwordx4 v[48:51], v88, s[24:27], s42 offen sc1
    s_add_u32 s55, s55, 25600
    ds_read_b64_tr_b16 v[52:53], v27 offset:25600
    ds_read_b64_tr_b16 v[54:55], v28 offset:25600
    ds_read_b64_tr_b16 v[56:57], v27 offset:25608
    ds_read_b64_tr_b16 v[58:59], v28 offset:25608
    ds_read_b64_tr_b16 v[60:61], v27 offset:25616
    ds_read_b64_tr_b16 v[62:63], v28 offset:25616
    ds_read_b64_tr_b16 v[64:65], v27 offset:25624
    ds_read_b64_tr_b16 v[66:67], v28 offset:25624
    ds_read_b64_tr_b16 v[68:69], v27 offset:25632
    ds_read_b64_tr_b16 v[70:71], v28 offset:25632
    s_add_u32 s42, s55, 4096
    s_waitcnt lgkmcnt(8)
    buffer_store_dwordx4 v[52:55], v88, s[24:27], s55 offen offset:0 sc1
    s_waitcnt lgkmcnt(6)
    buffer_store_dwordx4 v[56:59], v88, s[24:27], s55 offen offset:1024 sc1
    s_waitcnt lgkmcnt(4)
    buffer_store_dwordx4 v[60:63], v88, s[24:27], s55 offen offset:2048 sc1
    s_waitcnt lgkmcnt(2)
    buffer_store_dwordx4 v[64:67], v88, s[24:27], s55 offen offset:3072 sc1
    s_waitcnt lgkmcnt(0)
    buffer_store_dwordx4 v[68:71], v88, s[24:27], s42 offen sc1
    s_add_u32 s55, s55, 25600
K_SP2:
    buffer_load_dwordx2 v[90:91], v94, s[28:31], 0 offen sc1
    s_waitcnt vmcnt(0)
    s_barrier
    s_mov_b32 s45, 0
    s_branch K_SPN_C
K_SPN:
    s_sleep 2
    buffer_load_dwordx2 v[90:91], v94, s[28:31], 0 offen sc1
    s_waitcnt vmcnt(0)
K_SPN_C:
    v_readfirstlane_b32 s10, v90
    v_readfirstlane_b32 s11, v91
    s_add_u32 s45, s45, 1
    s_cmp_gt_u32 s45, 0x40000
    s_cbranch_scc1 K_SPN_D
    s_min_u32 s44, s10, s11
    s_cmp_eq_u32 s44, 0
    s_cbranch_scc1 K_SPN
K_SPN_D:
    s_cmp_lg_u32 s36, 0
    s_cbranch_scc1 K_SP3
    v_mov_b32 v90, s10
    v_mov_b32 v91, s11
    s_lshl_b32 s45, s61, 7
    s_add_u32 s45, s45, 22618112
    s_mov_b64 exec, 1
    buffer_store_dwordx2 v[90:91], v94, s[24:27], s45 offen sc1
    s_mov_b64 exec, -1
K_SP3:
    v_mov_b32 v95, 0
    s_mov_b32 s4, 0x40000000
    s_mov_b32 s5, 0x40000000
    s_mov_b32 s6, 0x40000000
    s_mov_b32 s7, 0x40000000
    s_mov_b32 s71, 0
    s_cmp_ge_u32 s36, 6
    s_cbranch_scc1 K_SHS_V
    v_mov_b32 v90, v88
    v_lshrrev_b32 v91, 1, v1
    v_and_b32 v89, 1, v1
    v_lshlrev_b32 v89, 2, v89
    v_lshl_add_u32 v91, v91, 4, v89
    s_add_u32 s46, s59, 10485760
    s_add_u32 s47, s46, s60
    s_sub_u32 s47, s47, 1024
    s_mov_b32 s48, 0
    s_branch K_SHS_G
K_SHS_V:
    v_mul_u32_u24 v91, 13, v1
    v_lshrrev_b32 v91, 8, v91
    v_mul_u32_u24 v89, 20, v91
    v_sub_u32 v89, v1, v89
    v_mul_u32_u24 v91, 10240, v91
    v_lshl_add_u32 v90, v89, 4, v91
    v_lshlrev_b32 v91, 2, v1
    s_mul_i32 s46, s56, 320
    s_add_u32 s46, s46, 13107200
    s_add_u32 s47, s46, 29760
    s_mov_b32 s48, 81920
K_SHS_G:
    s_and_b32 s44, s36, 1
    s_mul_i32 s45, s44, 163840
    s_add_u32 s46, s46, s45
    s_add_u32 s47, s47, s45
    s_mul_i32 s45, s44, 5120
    s_add_u32 s48, s48, s45
    s_lshl_b32 s51, 0x10001, s44
    s_mov_b32 s49, 0
    s_mov_b32 s50, -1
    s_cmp_lt_u32 s36, 4
    s_cbranch_scc1 K_P2
    s_mov_b32 s45, 0
K_SR1:
    s_cmp_ge_u32 s49, 1
    s_cbranch_scc1 K_SR1_D
    s_and_b32 s44, s50, s51
    s_cbranch_scc0 K_SR1_G
    s_mov_b32 s44, 22618112
    buffer_load_dwordx2 v[136:137], v0, s[24:27], s44 offen sc1
    s_waitcnt vmcnt(0)
    v_xor_b32 v136, s10, v136
    v_xor_b32 v137, s11, v137
    v_or_b32 v136, v136, v137
    v_cmp_ne_u32 vcc, 0, v136
    s_add_u32 s45, s45, 1
    s_cmp_gt_u32 s45, 0x40000
    s_cselect_b32 s50, 0, vcc_lo
    s_and_b32 s44, s50, s51
    s_cbranch_scc0 K_SR1_G
    s_sleep 3
    s_branch K_SR1
K_SR1_G:
    s_add_u32 m0, s48, 0
    s_nop 0
    buffer_load_dwordx4 v90, s[24:27], s46 offen sc1 lds
    buffer_load_dword v91, s[24:27], s47 offen offset:1024 sc1 lds
    s_add_u32 s46, s46, 40960
    s_add_u32 s47, s47, 40960
    s_add_u32 m0, s48, 1280
    s_nop 0
    buffer_load_dwordx4 v90, s[24:27], s46 offen sc1 lds
    buffer_load_dword v91, s[24:27], s47 offen offset:1024 sc1 lds
    s_add_u32 s46, s46, 40960
    s_add_u32 s47, s47, 40960
    s_add_u32 m0, s48, 2560
    s_nop 0
    buffer_load_dwordx4 v90, s[24:27], s46 offen sc1 lds
    buffer_load_dword v91, s[24:27], s47 offen offset:1024 sc1 lds
    s_add_u32 s46, s46, 40960
    s_add_u32 s47, s47, 40960
    s_add_u32 m0, s48, 3840
    s_nop 0
    buffer_load_dwordx4 v90, s[24:27], s46 offen sc1 lds
    buffer_load_dword v91, s[24:27], s47 offen offset:1024 sc1 lds
    s_add_u32 s46, s46, 204800
    s_add_u32 s47, s47, 204800
    s_add_u32 s48, s48, 10240
    s_add_u32 s49, s49, 1
    s_lshl_b32 s51, s51, 2
    s_branch K_SR1
K_SR1_D:
    s_waitcnt vmcnt(0)
    s_barrier
    s_setprio 1
    s_mov_b32 s45, 0
K_SR3:
    s_cmp_ge_u32 s49, 3
    s_cbranch_scc1 K_SR3_D
    s_and_b32 s44, s50, s51
    s_cbranch_scc0 K_SR3_G
    s_mov_b32 s44, 22618112
    buffer_load_dwordx2 v[136:137], v0, s[24:27], s44 offen sc1
    s_waitcnt vmcnt(0)
    v_xor_b32 v136, s10, v136
    v_xor_b32 v137, s11, v137
    v_or_b32 v136, v136, v137
    v_cmp_ne_u32 vcc, 0, v136
    s_add_u32 s45, s45, 1
    s_cmp_gt_u32 s45, 0x40000
    s_cselect_b32 s50, 0, vcc_lo
    s_and_b32 s44, s50, s51
    s_cbranch_scc0 K_SR3_G
    s_sleep 3
    s_branch K_SR3
K_SR3_G:
    s_add_u32 m0, s48, 0
    s_nop 0
    buffer_load_dwordx4 v90, s[24:27], s46 offen sc1 lds
    buffer_load_dword v91, s[24:27], s47 offen offset:1024 sc1 lds
    s_add_u32 s46, s46, 40960
    s_add_u32 s47, s47, 40960
    s_add_u32 m0, s48, 1280
    s_nop 0
    buffer_load_dwordx4 v90, s[24:27], s46 offen sc1 lds
    buffer_load_dword v91, s[24:27], s47 offen offset:1024 sc1 lds
    s_add_u32 s46, s46, 40960
    s_add_u32 s47, s47, 40960
    s_add_u32 m0, s48, 2560
    s_nop 0
    buffer_load_dwordx4 v90, s[24:27], s46 offen sc1 lds
    buffer_load_dword v91, s[24:27], s47 offen offset:1024 sc1 lds
    s_add_u32 s46, s46, 40960
    s_add_u32 s47, s47, 40960
    s_add_u32 m0, s48, 3840
    s_nop 0
    buffer_load_dwordx4 v90, s[24:27], s46 offen sc1 lds
    buffer_load_dword v91, s[24:27], s47 offen offset:1024 sc1 lds
    s_add_u32 s46, s46, 204800
    s_add_u32 s47, s47, 204800
    s_add_u32 s48, s48, 10240
    s_add_u32 s49, s49, 1
    s_lshl_b32 s51, s51, 2
    s_branch K_SR3
K_SR3_D:
K_P2:
    s_cmp_ge_u32 s36, 4
    s_cbranch_scc1 K2_HELP
    v_mov_b32 v5, v88
    v_lshlrev_b32 v8, 3, v92
    v_add_u32 v8, 1024, v8
    v_mul_u32_u24 v11, 320, v93
    v_lshl_add_u32 v6, v92, 4, v11
    v_add_u32 v6, 81920, v6
    v_and_b32 v11, 27, v92
    v_cmp_eq_u32 vcc, 24, v11
    v_mov_b32 v12, 0x3f803f80
    s_nop 0
    v_cndmask_b32 v11, 0, v12, vcc
    v_mov_b32 v120, v11
    v_mov_b32 v121, v11
    v_mov_b32 v122, v11
    v_mov_b32 v123, v11
    v_mov_b32 v124, v11
    v_mov_b32 v125, v11
    v_mov_b32 v126, v11
    v_mov_b32 v127, v11
    v_mov_b32 v128, v11
    v_mov_b32 v129, v11
    v_mov_b32 v130, v11
    v_mov_b32 v131, v11
    v_mov_b32 v132, v11
    v_mov_b32 v133, v11
    v_mov_b32 v134, v11
    v_mov_b32 v135, v11
    v_mov_b32 v28, v11
    v_mov_b32 v29, v11
    v_mov_b32 v30, v11
    v_mov_b32 v31, v11
    v_mov_b32 v32, v11
    v_mov_b32 v33, v11
    v_mov_b32 v34, v11
    v_mov_b32 v35, v11
    v_mov_b32 v36, v11
    v_mov_b32 v37, v11
    v_mov_b32 v38, v11
    v_mov_b32 v39, v11
    v_mov_b32 v40, v11
    v_mov_b32 v41, v11
    v_mov_b32 v42, v11
    v_mov_b32 v43, v11
    v_mov_b32 v224, 0
    v_mov_b32 v225, 0
    v_mov_b32 v226, 0
    v_mov_b32 v227, 0
    v_mov_b32 v228, 0
    v_mov_b32 v229, 0
    v_mov_b32 v230, 0
    v_mov_b32 v231, 0
    v_mov_b32 v232, 0
    v_mov_b32 v233, 0
    v_mov_b32 v234, 0
    v_mov_b32 v235, 0
    v_mov_b32 v236, 0
    v_mov_b32 v237, 0
    v_mov_b32 v238, 0
    v_mov_b32 v239, 0
    v_mov_b32 v240, 0
    v_mov_b32 v241, 0
    v_mov_b32 v242, 0
    v_mov_b32 v243, 0
    v_mov_b32 v244, 0
    v_mov_b32 v245, 0
    v_mov_b32 v246, 0
    v_mov_b32 v247, 0
    v_mov_b32 v248, 0
    v_mov_b32 v249, 0
    v_mov_b32 v250, 0
    v_mov_b32 v251, 0
    v_mov_b32 v252, 0
    v_mov_b32 v253, 0
    v_mov_b32 v254, 0
    v_mov_b32 v255, 0
    v_mov_b32 v144, 0
    v_mov_b32 v145, 0
    v_mov_b32 v146, 0
    v_mov_b32 v147, 0
    v_mov_b32 v148, 0
    v_mov_b32 v149, 0
    v_mov_b32 v150, 0
    v_mov_b32 v151, 0
    s_lshl_b32 s46, s57, 7
    s_add_u32 s46, s46, 22609920
    v_lshlrev_b32 v89, 2, v92
    s_cmp_eq_u32 s71, 1
    s_cbranch_scc1 K2_HAVEQ
    s_mov_b32 s45, 0
K2_PQ:
    s_mov_b32 s44, 22618112
    buffer_load_dwordx2 v[136:137], v0, s[24:27], s44 offen sc1
K2_PQ_C:
    s_waitcnt vmcnt(0)
    v_xor_b32 v136, s10, v136
    v_xor_b32 v137, s11, v137
    v_or_b32 v136, v136, v137
    v_cmp_ne_u32 vcc, 0, v136
    s_add_u32 s45, s45, 1
    s_cmp_eq_u64 vcc, 0
    s_cbranch_scc1 K2_PQ_D
    s_sleep 3
    s_cmp_lt_u32 s45, 0x40000
    s_cbranch_scc1 K2_PQ
K2_PQ_D:
    v_mov_b32 v100, 0
    v_mov_b32 v101, 0
    v_mov_b32 v102, 0
    v_mov_b32 v103, 0
    s_add_u32 s44, s73, 7864320
    buffer_load_dwordx4 v[96:99], v88, s[24:27], s44 offen sc1
    s_add_u32 s45, s44, s60
    s_mov_b32 exec_hi, 0
    buffer_load_dwordx2 v[100:101], v88, s[24:27], s45 offen sc1
    s_mov_b32 exec_hi, -1
    s_add_u32 s44, s73, 7905280
    buffer_load_dwordx4 v[104:107], v88, s[24:27], s44 offen sc1
    s_add_u32 s45, s44, s60
    s_mov_b32 exec_hi, 0
    buffer_load_dwordx2 v[102:103], v88, s[24:27], s45 offen sc1
    s_mov_b32 exec_hi, -1
K2_HAVEQ:
    buffer_store_dwordx4 v[72:75], v95, s[24:27], s4 offen sc1
    buffer_store_dwordx4 v[76:79], v95, s[24:27], s5 offen sc1
    buffer_store_dwordx4 v[80:83], v95, s[24:27], s6 offen sc1
    buffer_store_dwordx4 v[84:87], v95, s[24:27], s7 offen sc1
    s_mov_b32 s70, 1
    s_mov_b32 s71, 0
    s_mov_b32 s69, 1
    s_waitcnt vmcnt(4)
    s_barrier
K2_RESTART:
    v_mov_b32 v11, 0xff800000
    v_mov_b32 v12, 0xff800000
    v_mov_b32 v3, v5
    v_mov_b32 v7, v8
K2_MAXP:
    ds_read_b128 v[108:111], v3
    ds_read_b64 v[112:113], v7
    s_waitcnt lgkmcnt(0)
    v_mfma_f32_32x32x16_bf16 v[192:207], v[108:111], v[96:99], 0
    v_mfma_f32_32x32x16_bf16 v[208:223], v[108:111], v[104:107], 0
    v_mfma_f32_32x32x8_bf16 v[192:207], v[112:113], v[100:101], v[192:207]
    v_mfma_f32_32x32x8_bf16 v[208:223], v[112:113], v[102:103], v[208:223]
    v_add_u32 v3, 1280, v3
    v_add_u32 v7, 1280, v7
    s_nop 9
    v_max3_f32 v11, v11, v192, v193
    v_max3_f32 v11, v11, v194, v195
    v_max3_f32 v11, v11, v196, v197
    v_max3_f32 v11, v11, v198, v199
    v_max3_f32 v11, v11, v200, v201
    v_max3_f32 v11, v11, v202, v203
    v_max3_f32 v11, v11, v204, v205
    v_max3_f32 v11, v11, v206, v207
    v_max3_f32 v12, v12, v208, v209
    v_max3_f32 v12, v12, v210, v211
    v_max3_f32 v12, v12, v212, v213
    v_max3_f32 v12, v12, v214, v215
    v_max3_f32 v12, v12, v216, v217
    v_max3_f32 v12, v12, v218, v219
    v_max3_f32 v12, v12, v220, v221
    v_max3_f32 v12, v12, v222, v223
    s_sub_u32 s70, s70, 1
    s_cmp_lg_u32 s70, 0
    s_cbranch_scc1 K2_MAXP
    ds_read_b128 v[108:111], v5 offset:0
    ds_read_b64 v[112:113], v8 offset:0
    ds_read_b128 v[116:119], v5 offset:1280
    ds_read_b64 v[114:115], v8 offset:1280
    s_mov_b64 exec, s[62:63]
    ds_read_b128 v[120:123], v6
    ds_read_b128 v[124:127], v6 offset:640
    ds_read_b128 v[128:131], v6 offset:1280
    ds_read_b128 v[132:135], v6 offset:1920
    s_mov_b64 exec, -1
    v_mov_b32 v13, v11
    v_mov_b32 v14, v12
    s_nop 1
    v_permlane32_swap_b32 v11, v13
    v_permlane32_swap_b32 v12, v14
    s_nop 1
    v_max_f32 v11, v11, v13
    v_max_f32 v12, v12, v14
    v_sub_f32 v160, 0, v11
    v_sub_f32 v161, 0, v11
    v_pk_mov_b32 v[162:163], v[160:161], v[160:161]
    v_pk_mov_b32 v[164:165], v[160:161], v[160:161]
    v_pk_mov_b32 v[166:167], v[160:161], v[160:161]
    v_pk_mov_b32 v[168:169], v[160:161], v[160:161]
    v_pk_mov_b32 v[170:171], v[160:161], v[160:161]
    v_pk_mov_b32 v[172:173], v[160:161], v[160:161]
    v_pk_mov_b32 v[174:175], v[160:161], v[160:161]
    s_waitcnt lgkmcnt(0)
    s_nop 0
    v_mfma_f32_32x32x16_bf16 v[192:207], v[108:111], v[96:99], v[160:175]
    v_sub_f32 v176, 0, v12
    v_sub_f32 v177, 0, v12
    v_pk_mov_b32 v[178:179], v[176:177], v[176:177]
    v_pk_mov_b32 v[180:181], v[176:177], v[176:177]
    v_pk_mov_b32 v[182:183], v[176:177], v[176:177]
    v_pk_mov_b32 v[184:185], v[176:177], v[176:177]
    v_pk_mov_b32 v[186:187], v[176:177], v[176:177]
    v_pk_mov_b32 v[188:189], v[176:177], v[176:177]
    v_pk_mov_b32 v[190:191], v[176:177], v[176:177]
    v_mfma_f32_32x32x8_bf16 v[192:207], v[112:113], v[100:101], v[192:207]
    v_mov_b32 v3, v5
    v_mov_b32 v7, v8
    v_mov_b32 v4, v6
    s_mov_b32 s68, 0
    s_nop 5
.p2align 3
K2_LOOP:
    s_cmp_eq_u32 s68, s69
    s_cbranch_scc1 K2_SYNC
K2_NOSYNC:
    v_mfma_f32_32x32x16_bf16 v[208:223], v[108:111], v[104:107], v[176:191]
    ds_read_b128 v[108:111], v3 offset:2560
    v_exp_f32 v192, v192
    v_exp_f32 v193, v193
    v_exp_f32 v194, v194
    v_exp_f32 v195, v195
    v_cvt_pk_bf16_f32 v136, v192, v193
    v_cvt_pk_bf16_f32 v137, v194, v195
    v_mfma_f32_32x32x16_bf16 v[240:255], v[36:39], v[144:147], v[240:255]
    v_exp_f32 v196, v196
    v_exp_f32 v197, v197
    v_exp_f32 v198, v198
    v_exp_f32 v199, v199
    v_cvt_pk_bf16_f32 v138, v196, v197
    v_cvt_pk_bf16_f32 v139, v198, v199
    v_mfma_f32_32x32x8_bf16 v[208:223], v[112:113], v[102:103], v[208:223]
    ds_read_b64 v[112:113], v7 offset:2560
    v_exp_f32 v200, v200
    v_exp_f32 v201, v201
    v_exp_f32 v202, v202
    v_exp_f32 v203, v203
    v_cvt_pk_bf16_f32 v140, v200, v201
    v_cvt_pk_bf16_f32 v141, v202, v203
    v_mfma_f32_32x32x16_bf16 v[240:255], v[40:43], v[148:151], v[240:255]
    s_mov_b64 exec, s[62:63]
    ds_read_b128 v[28:31], v4 offset:2560
    ds_read_b128 v[32:35], v4 offset:3200
    ds_read_b128 v[36:39], v4 offset:3840
    ds_read_b128 v[40:43], v4 offset:4480
    s_mov_b64 exec, -1
    v_exp_f32 v204, v204
    v_exp_f32 v205, v205
    v_exp_f32 v206, v206
    v_exp_f32 v207, v207
    s_waitcnt lgkmcnt(6)
    v_cvt_pk_bf16_f32 v142, v204, v205
    v_cvt_pk_bf16_f32 v143, v206, v207
    v_mfma_f32_32x32x16_bf16 v[192:207], v[116:119], v[96:99], v[160:175]
    v_exp_f32 v208, v208
    v_exp_f32 v209, v209
    v_exp_f32 v210, v210
    v_exp_f32 v211, v211
    v_cvt_pk_bf16_f32 v144, v208, v209
    v_cvt_pk_bf16_f32 v145, v210, v211
    v_mfma_f32_32x32x16_bf16 v[224:239], v[120:123], v[136:139], v[224:239]
    v_exp_f32 v212, v212
    v_exp_f32 v213, v213
    v_exp_f32 v214, v214
    v_exp_f32 v215, v215
    v_cvt_pk_bf16_f32 v146, v212, v213
    v_cvt_pk_bf16_f32 v147, v214, v215
    v_mfma_f32_32x32x8_bf16 v[192:207], v[114:115], v[100:101], v[192:207]
    v_exp_f32 v216, v216
    v_exp_f32 v217, v217
    v_exp_f32 v218, v218
    v_exp_f32 v219, v219
    v_cvt_pk_bf16_f32 v148, v216, v217
    v_cvt_pk_bf16_f32 v149, v218, v219
    v_mfma_f32_32x32x16_bf16 v[224:239], v[124:127], v[140:143], v[224:239]
    v_exp_f32 v220, v220
    v_exp_f32 v221, v221
    v_exp_f32 v222, v222
    v_exp_f32 v223, v223
    v_cvt_pk_bf16_f32 v150, v220, v221
    v_cvt_pk_bf16_f32 v151, v222, v223
    v_mfma_f32_32x32x16_bf16 v[208:223], v[116:119], v[104:107], v[176:191]
    ds_read_b128 v[116:119], v3 offset:3840
    v_exp_f32 v192, v192
    v_exp_f32 v193, v193
    v_exp_f32 v194, v194
    v_exp_f32 v195, v195
    v_cvt_pk_bf16_f32 v136, v192, v193
    v_cvt_pk_bf16_f32 v137, v194, v195
    v_mfma_f32_32x32x16_bf16 v[240:255], v[120:123], v[144:147], v[240:255]
    v_exp_f32 v196, v196
    v_exp_f32 v197, v197
    v_exp_f32 v198, v198
    v_exp_f32 v199, v199
    v_cvt_pk_bf16_f32 v138, v196, v197
    v_cvt_pk_bf16_f32 v139, v198, v199
    v_mfma_f32_32x32x8_bf16 v[208:223], v[114:115], v[102:103], v[208:223]
    ds_read_b64 v[114:115], v7 offset:3840
    v_exp_f32 v200, v200
    v_exp_f32 v201, v201
    v_exp_f32 v202, v202
    v_exp_f32 v203, v203
    v_cvt_pk_bf16_f32 v140, v200, v201
    v_cvt_pk_bf16_f32 v141, v202, v203
    v_mfma_f32_32x32x16_bf16 v[240:255], v[124:127], v[148:151], v[240:255]
    v_exp_f32 v204, v204
    v_exp_f32 v205, v205
    v_exp_f32 v206, v206
    v_exp_f32 v207, v207
    s_waitcnt lgkmcnt(2)
    v_cvt_pk_bf16_f32 v142, v204, v205
    v_cvt_pk_bf16_f32 v143, v206, v207
    v_mfma_f32_32x32x16_bf16 v[192:207], v[108:111], v[96:99], v[160:175]
    v_exp_f32 v208, v208
    v_exp_f32 v209, v209
    v_exp_f32 v210, v210
    v_exp_f32 v211, v211
    v_cvt_pk_bf16_f32 v144, v208, v209
    v_cvt_pk_bf16_f32 v145, v210, v211
    v_mfma_f32_32x32x16_bf16 v[224:239], v[128:131], v[136:139], v[224:239]
    v_exp_f32 v212, v212
    v_exp_f32 v213, v213
    v_exp_f32 v214, v214
    v_exp_f32 v215, v215
    v_cvt_pk_bf16_f32 v146, v212, v213
    v_cvt_pk_bf16_f32 v147, v214, v215
    v_mfma_f32_32x32x8_bf16 v[192:207], v[112:113], v[100:101], v[192:207]
    v_exp_f32 v216, v216
    v_exp_f32 v217, v217
    v_exp_f32 v218, v218
    v_exp_f32 v219, v219
    v_cvt_pk_bf16_f32 v148, v216, v217
    v_cvt_pk_bf16_f32 v149, v218, v219
    v_mfma_f32_32x32x16_bf16 v[224:239], v[132:135], v[140:143], v[224:239]
    v_exp_f32 v220, v220
    v_exp_f32 v221, v221
    v_exp_f32 v222, v222
    v_exp_f32 v223, v223
    v_cvt_pk_bf16_f32 v150, v220, v221
    v_cvt_pk_bf16_f32 v151, v222, v223
    v_mfma_f32_32x32x16_bf16 v[208:223], v[108:111], v[104:107], v[176:191]
    ds_read_b128 v[108:111], v3 offset:5120
    v_exp_f32 v192, v192
    v_exp_f32 v193, v193
    v_exp_f32 v194, v194
    v_exp_f32 v195, v195
    v_cvt_pk_bf16_f32 v136, v192, v193
    v_cvt_pk_bf16_f32 v137, v194, v195
    v_mfma_f32_32x32x16_bf16 v[240:255], v[128:131], v[144:147], v[240:255]
    v_exp_f32 v196, v196
    v_exp_f32 v197, v197
    v_exp_f32 v198, v198
    v_exp_f32 v199, v199
    v_cvt_pk_bf16_f32 v138, v196, v197
    v_cvt_pk_bf16_f32 v139, v198, v199
    v_mfma_f32_32x32x8_bf16 v[208:223], v[112:113], v[102:103], v[208:223]
    ds_read_b64 v[112:113], v7 offset:5120
    v_exp_f32 v200, v200
    v_exp_f32 v201, v201
    v_exp_f32 v202, v202
    v_exp_f32 v203, v203
    v_cvt_pk_bf16_f32 v140, v200, v201
    v_cvt_pk_bf16_f32 v141, v202, v203
    v_mfma_f32_32x32x16_bf16 v[240:255], v[132:135], v[148:151], v[240:255]
    s_mov_b64 exec, s[62:63]
    ds_read_b128 v[120:123], v4 offset:5120
    ds_read_b128 v[124:127], v4 offset:5760
    ds_read_b128 v[128:131], v4 offset:6400
    ds_read_b128 v[132:135], v4 offset:7040
    s_mov_b64 exec, -1
    v_exp_f32 v204, v204
    v_exp_f32 v205, v205
    v_exp_f32 v206, v206
    v_exp_f32 v207, v207
    s_waitcnt lgkmcnt(6)
    v_cvt_pk_bf16_f32 v142, v204, v205
    v_cvt_pk_bf16_f32 v143, v206, v207
    v_mfma_f32_32x32x16_bf16 v[192:207], v[116:119], v[96:99], v[160:175]
    v_exp_f32 v208, v208
    v_exp_f32 v209, v209
    v_exp_f32 v210, v210
    v_exp_f32 v211, v211
    v_cvt_pk_bf16_f32 v144, v208, v209
    v_cvt_pk_bf16_f32 v145, v210, v211
    v_mfma_f32_32x32x16_bf16 v[224:239], v[28:31], v[136:139], v[224:239]
    v_exp_f32 v212, v212
    v_exp_f32 v213, v213
    v_exp_f32 v214, v214
    v_exp_f32 v215, v215
    v_cvt_pk_bf16_f32 v146, v212, v213
    v_cvt_pk_bf16_f32 v147, v214, v215
    v_mfma_f32_32x32x8_bf16 v[192:207], v[114:115], v[100:101], v[192:207]
    v_exp_f32 v216, v216
    v_exp_f32 v217, v217
    v_exp_f32 v218, v218
    v_exp_f32 v219, v219
    v_cvt_pk_bf16_f32 v148, v216, v217
    v_cvt_pk_bf16_f32 v149, v218, v219
    v_mfma_f32_32x32x16_bf16 v[224:239], v[32:35], v[140:143], v[224:239]
    v_exp_f32 v220, v220
    v_exp_f32 v221, v221
    v_exp_f32 v222, v222
    v_exp_f32 v223, v223
    v_cvt_pk_bf16_f32 v150, v220, v221
    v_cvt_pk_bf16_f32 v151, v222, v223
    v_mfma_f32_32x32x16_bf16 v[208:223], v[116:119], v[104:107], v[176:191]
    ds_read_b128 v[116:119], v3 offset:6400
    v_exp_f32 v192, v192
    v_exp_f32 v193, v193
    v_exp_f32 v194, v194
    v_exp_f32 v195, v195
    v_cvt_pk_bf16_f32 v136, v192, v193
    v_cvt_pk_bf16_f32 v137, v194, v195
    v_mfma_f32_32x32x16_bf16 v[240:255], v[28:31], v[144:147], v[240:255]
    v_exp_f32 v196, v196
    v_exp_f32 v197, v197
    v_exp_f32 v198, v198
    v_exp_f32 v199, v199
    v_cvt_pk_bf16_f32 v138, v196, v197
    v_cvt_pk_bf16_f32 v139, v198, v199
    v_mfma_f32_32x32x8_bf16 v[208:223], v[114:115], v[102:103], v[208:223]
    ds_read_b64 v[114:115], v7 offset:6400
    v_exp_f32 v200, v200
    v_exp_f32 v201, v201
    v_exp_f32 v202, v202
    v_exp_f32 v203, v203
    v_cvt_pk_bf16_f32 v140, v200, v201
    v_cvt_pk_bf16_f32 v141, v202, v203
    v_mfma_f32_32x32x16_bf16 v[240:255], v[32:35], v[148:151], v[240:255]
    v_exp_f32 v204, v204
    v_exp_f32 v205, v205
    v_exp_f32 v206, v206
    v_exp_f32 v207, v207
    s_waitcnt lgkmcnt(2)
    v_cvt_pk_bf16_f32 v142, v204, v205
    v_cvt_pk_bf16_f32 v143, v206, v207
    v_mfma_f32_32x32x16_bf16 v[192:207], v[108:111], v[96:99], v[160:175]
    v_exp_f32 v208, v208
    v_exp_f32 v209, v209
    v_exp_f32 v210, v210
    v_exp_f32 v211, v211
    v_cvt_pk_bf16_f32 v144, v208, v209
    v_cvt_pk_bf16_f32 v145, v210, v211
    v_mfma_f32_32x32x16_bf16 v[224:239], v[36:39], v[136:139], v[224:239]
    v_exp_f32 v212, v212
    v_exp_f32 v213, v213
    v_exp_f32 v214, v214
    v_exp_f32 v215, v215
    v_cvt_pk_bf16_f32 v146, v212, v213
    v_cvt_pk_bf16_f32 v147, v214, v215
    v_mfma_f32_32x32x8_bf16 v[192:207], v[112:113], v[100:101], v[192:207]
    v_exp_f32 v216, v216
    v_exp_f32 v217, v217
    v_exp_f32 v218, v218
    v_exp_f32 v219, v219
    v_cvt_pk_bf16_f32 v148, v216, v217
    v_cvt_pk_bf16_f32 v149, v218, v219
    v_mfma_f32_32x32x16_bf16 v[224:239], v[40:43], v[140:143], v[224:239]
    v_exp_f32 v220, v220
    s_add_u32 s68, s68, 1
    v_exp_f32 v221, v221
    s_cmp_lt_u32 s68, 16
    v_exp_f32 v222, v222
    v_exp_f32 v223, v223
    v_cvt_pk_bf16_f32 v150, v220, v221
    v_cvt_pk_bf16_f32 v151, v222, v223
    v_add_u32 v3, 5120, v3
    v_add_u32 v7, 5120, v7
    v_add_u32 v4, 5120, v4
    s_cbranch_scc1 K2_LOOP
    s_waitcnt lgkmcnt(0)
    v_mfma_f32_32x32x16_bf16 v[240:255], v[36:39], v[144:147], v[240:255]
    v_mfma_f32_32x32x16_bf16 v[240:255], v[40:43], v[148:151], v[240:255]
    v_mov_b32 v15, 0x5f800000
    v_pk_mul_f32 v[20:21], v[224:225], 0
    v_pk_fma_f32 v[20:21], v[226:227], 0, v[20:21]
    v_pk_fma_f32 v[20:21], v[228:229], 0, v[20:21]
    v_pk_fma_f32 v[20:21], v[230:231], 0, v[20:21]
    v_pk_fma_f32 v[20:21], v[232:233], 0, v[20:21]
    v_pk_fma_f32 v[20:21], v[234:235], 0, v[20:21]
    v_rcp_f32 v13, v236
    v_add_f32 v20, v20, v21
    v_add_f32 v11, v20, v236
    s_nop 3
    v_pk_mul_f32 v[22:23], v[240:241], 0
    v_pk_fma_f32 v[22:23], v[242:243], 0, v[22:23]
    v_pk_fma_f32 v[22:23], v[244:245], 0, v[22:23]
    v_pk_fma_f32 v[22:23], v[246:247], 0, v[22:23]
    v_pk_fma_f32 v[22:23], v[248:249], 0, v[22:23]
    v_pk_fma_f32 v[22:23], v[250:251], 0, v[22:23]
    v_rcp_f32 v14, v252
    v_add_f32 v22, v22, v23
    v_add_f32 v12, v22, v252
    v_cmp_nle_f32 s[66:67], v11, v15
    v_cmp_nle_f32 vcc, v12, v15
    s_waitcnt vmcnt(0)
    s_or_b64 s[66:67], s[66:67], vcc
    s_cbranch_scc0 K2_OUT
    s_cmp_lg_u32 s71, 0
    s_cbranch_scc1 K2_OUT
    s_mov_b32 s71, 1
    s_mov_b32 s70, 64
    s_mov_b32 s69, -1
    v_mov_b32 v224, 0
    v_mov_b32 v225, 0
    v_mov_b32 v226, 0
    v_mov_b32 v227, 0
    v_mov_b32 v228, 0
    v_mov_b32 v229, 0
    v_mov_b32 v230, 0
    v_mov_b32 v231, 0
    v_mov_b32 v232, 0
    v_mov_b32 v233, 0
    v_mov_b32 v234, 0
    v_mov_b32 v235, 0
    v_mov_b32 v236, 0
    v_mov_b32 v237, 0
    v_mov_b32 v238, 0
    v_mov_b32 v239, 0
    v_mov_b32 v240, 0
    v_mov_b32 v241, 0
    v_mov_b32 v242, 0
    v_mov_b32 v243, 0
    v_mov_b32 v244, 0
    v_mov_b32 v245, 0
    v_mov_b32 v246, 0
    v_mov_b32 v247, 0
    v_mov_b32 v248, 0
    v_mov_b32 v249, 0
    v_mov_b32 v250, 0
    v_mov_b32 v251, 0
    v_mov_b32 v252, 0
    v_mov_b32 v253, 0
    v_mov_b32 v254, 0
    v_mov_b32 v255, 0
    v_mov_b32 v144, 0
    v_mov_b32 v145, 0
    v_mov_b32 v146, 0
    v_mov_b32 v147, 0
    v_mov_b32 v148, 0
    v_mov_b32 v149, 0
    v_mov_b32 v150, 0
    v_mov_b32 v151, 0
    s_branch K2_RESTART
K2_OUT:
    v_sub_f32 v11, 1.0, v90
    v_sub_f32 v12, 1.0, v91
    v_mul_f32 v20, v11, v13
    v_mul_f32 v22, v12, v14
    v_pk_mul_f32 v[224:225], v[224:225], v[20:21] op_sel_hi:[1,0]
    v_pk_mul_f32 v[226:227], v[226:227], v[20:21] op_sel_hi:[1,0]
    v_pk_mul_f32 v[228:229], v[228:229], v[20:21] op_sel_hi:[1,0]
    v_pk_mul_f32 v[230:231], v[230:231], v[20:21] op_sel_hi:[1,0]
    v_pk_mul_f32 v[232:233], v[232:233], v[20:21] op_sel_hi:[1,0]
    v_pk_mul_f32 v[234:235], v[234:235], v[20:21] op_sel_hi:[1,0]
    v_cvt_pk_bf16_f32 v136, v224, v225
    v_cvt_pk_bf16_f32 v137, v226, v227
    v_cvt_pk_bf16_f32 v138, v228, v229
    v_cvt_pk_bf16_f32 v139, v230, v231
    v_cvt_pk_bf16_f32 v140, v232, v233
    v_cvt_pk_bf16_f32 v141, v234, v235
    s_add_u32 s41, s52, 0
    s_add_u32 s42, s53, 0
    buffer_store_dwordx4 v[136:139], v88, s[24:27], s41 offen sc1
    s_mov_b32 exec_hi, 0
    buffer_store_dwordx2 v[140:141], v88, s[24:27], s42 offen offset:2048 sc1
    s_mov_b32 exec_hi, -1
    v_pk_mul_f32 v[240:241], v[240:241], v[22:23] op_sel_hi:[1,0]
    v_pk_mul_f32 v[242:243], v[242:243], v[22:23] op_sel_hi:[1,0]
    v_pk_mul_f32 v[244:245], v[244:245], v[22:23] op_sel_hi:[1,0]
    v_pk_mul_f32 v[246:247], v[246:247], v[22:23] op_sel_hi:[1,0]
    v_pk_mul_f32 v[248:249], v[248:249], v[22:23] op_sel_hi:[1,0]
    v_pk_mul_f32 v[250:251], v[250:251], v[22:23] op_sel_hi:[1,0]
    v_cvt_pk_bf16_f32 v144, v240, v241
    v_cvt_pk_bf16_f32 v145, v242, v243
    v_cvt_pk_bf16_f32 v146, v244, v245
    v_cvt_pk_bf16_f32 v147, v246, v247
    v_cvt_pk_bf16_f32 v148, v248, v249
    v_cvt_pk_bf16_f32 v149, v250, v251
    s_add_u32 s41, s52, 81920
    s_add_u32 s42, s53, 81920
    buffer_store_dwordx4 v[144:147], v88, s[24:27], s41 offen sc1
    s_mov_b32 exec_hi, 0
    buffer_store_dwordx2 v[148:149], v88, s[24:27], s42 offen offset:2048 sc1
    s_mov_b32 exec_hi, -1
    s_barrier
    s_endpgm
K2_SYNC:
    s_waitcnt vmcnt(0)
    s_barrier
    s_cmp_eq_u32 s68, 1
    s_cselect_b32 s69, 2, 5
    s_cmp_lt_u32 s68, 5
    s_cbranch_scc1 K2_NOSYNC
    buffer_load_dword v90, v89, s[24:27], s46 offen sc1
    buffer_load_dword v91, v89, s[24:27], s46 offen offset:128 sc1
    s_branch K2_NOSYNC
K2_HELP:
    v_mul_u32_u24 v11, 10240, v93
    v_lshl_add_u32 v2, v92, 4, v11
    buffer_store_dwordx4 v[72:75], v95, s[24:27], s4 offen sc1
    buffer_store_dwordx4 v[76:79], v95, s[24:27], s5 offen sc1
    buffer_store_dwordx4 v[80:83], v95, s[24:27], s6 offen sc1
    buffer_store_dwordx4 v[84:87], v95, s[24:27], s7 offen sc1
    s_load_dwordx2 s[8:9], s[0:1], 56
    v_mov_b32 v100, 0
    v_mov_b32 v101, 0
    v_and_b32 v11, 27, v92
    v_cmp_eq_u32 vcc, 24, v11
    v_mov_b32 v12, 0x3f803f80
    s_nop 0
    v_cndmask_b32 v11, 0, v12, vcc
    v_mov_b32 v116, v11
    v_mov_b32 v117, v11
    v_mov_b32 v118, v11
    v_mov_b32 v119, v11
    v_mov_b32 v120, v11
    v_mov_b32 v121, v11
    v_mov_b32 v122, v11
    v_mov_b32 v123, v11
    v_mov_b32 v124, v11
    v_mov_b32 v125, v11
    v_mov_b32 v126, v11
    v_mov_b32 v127, v11
    v_mov_b32 v15, 0xff800000
    s_mov_b32 s64, 0x00005555
    s_mov_b32 s65, 0x00055550
    v_cndmask_b32_e64 v144, v15, 0, s[64:65]
    s_mov_b32 s64, 0x0000aaaa
    s_mov_b32 s65, 0x000aaaa0
    v_cndmask_b32_e64 v145, v15, 0, s[64:65]
    s_mov_b32 s64, 0x00015554
    s_mov_b32 s65, 0x00155540
    v_cndmask_b32_e64 v146, v15, 0, s[64:65]
    s_mov_b32 s64, 0x0002aaa8
    s_mov_b32 s65, 0x002aaa80
    v_cndmask_b32_e64 v147, v15, 0, s[64:65]
    s_mov_b32 s64, 0x00555500
    s_mov_b32 s65, 0x05555000
    v_cndmask_b32_e64 v148, v15, 0, s[64:65]
    s_mov_b32 s64, 0x00aaaa00
    s_mov_b32 s65, 0x0aaaa000
    v_cndmask_b32_e64 v149, v15, 0, s[64:65]
    s_mov_b32 s64, 0x01555400
    s_mov_b32 s65, 0x15554000
    v_cndmask_b32_e64 v150, v15, 0, s[64:65]
    s_mov_b32 s64, 0x02aaa800
    s_mov_b32 s65, 0x2aaa8000
    v_cndmask_b32_e64 v151, v15, 0, s[64:65]
    s_mov_b32 s64, 0x55550000
    s_mov_b32 s65, 0x55500000
    v_cndmask_b32_e64 v152, v15, 0, s[64:65]
    s_mov_b32 s64, 0xaaaa0000
    s_mov_b32 s65, 0xaaa00000
    v_cndmask_b32_e64 v153, v15, 0, s[64:65]
    s_mov_b32 s64, 0x55540000
    s_mov_b32 s65, 0x55400000
    v_cndmask_b32_e64 v154, v15, 0, s[64:65]
    s_mov_b32 s64, 0xaaa80000
    s_mov_b32 s65, 0xaa800000
    v_cndmask_b32_e64 v155, v15, 0, s[64:65]
    s_mov_b32 s64, 0x55000000
    s_mov_b32 s65, 0x50000000
    v_cndmask_b32_e64 v156, v15, 0, s[64:65]
    s_mov_b32 s64, 0xaa000000
    s_mov_b32 s65, 0xa0000000
    v_cndmask_b32_e64 v157, v15, 0, s[64:65]
    s_mov_b32 s64, 0x54000000
    s_mov_b32 s65, 0x40000000
    v_cndmask_b32_e64 v158, v15, 0, s[64:65]
    s_mov_b32 s64, 0xa8000000
    s_mov_b32 s65, 0x80000000
    v_cndmask_b32_e64 v159, v15, 0, s[64:65]
    v_mov_b32 v160, 0
    v_mov_b32 v161, 0
    v_mov_b32 v162, 0
    v_mov_b32 v163, 0
    v_mov_b32 v164, 0
    v_mov_b32 v165, 0
    v_mov_b32 v166, 0
    v_mov_b32 v167, 0
    s_cmp_eq_u32 s57, 0
    s_cselect_b32 s72, 0, -1
    s_and_b32 s64, s72, 0x00000000
    s_and_b32 s65, s72, 0x00000005
    v_cndmask_b32_e64 v168, v15, 0, s[64:65]
    s_and_b32 s64, s72, 0x00000000
    s_and_b32 s65, s72, 0x0000000a
    v_cndmask_b32_e64 v169, v15, 0, s[64:65]
    s_and_b32 s64, s72, 0x00000001
    s_and_b32 s65, s72, 0x00000015
    v_cndmask_b32_e64 v170, v15, 0, s[64:65]
    s_and_b32 s64, s72, 0x00000002
    s_and_b32 s65, s72, 0x0000002a
    v_cndmask_b32_e64 v171, v15, 0, s[64:65]
    s_and_b32 s64, s72, 0x00000055
    s_and_b32 s65, s72, 0x00000555
    v_cndmask_b32_e64 v172, v15, 0, s[64:65]
    s_and_b32 s64, s72, 0x000000aa
    s_and_b32 s65, s72, 0x00000aaa
    v_cndmask_b32_e64 v173, v15, 0, s[64:65]
    s_and_b32 s64, s72, 0x00000155
    s_and_b32 s65, s72, 0x00001555
    v_cndmask_b32_e64 v174, v15, 0, s[64:65]
    s_and_b32 s64, s72, 0x000002aa
    s_and_b32 s65, s72, 0x00002aaa
    v_cndmask_b32_e64 v175, v15, 0, s[64:65]
    s_mul_i32 s41, s56, 20
    s_add_u32 s42, s41, 19
    s_lshr_b32 s41, s41, 7
    s_lshr_b32 s42, s42, 7
    v_mov_b32 v11, s41
    v_mov_b32 v12, s42
    v_and_b32 v13, 1, v1
    v_cmp_eq_u32 vcc, 0, v13
    s_lshr_b32 s43, s57, 2
    s_sub_u32 s44, s57, 1
    s_max_i32 s44, s44, 0
    s_lshr_b32 s44, s44, 2
    v_cndmask_b32 v11, v12, v11, vcc
    v_bfe_u32 v12, v1, 2, 2
    v_min_u32 v12, 2, v12
    v_mad_u32_u24 v11, v12, 5, v11
    v_and_b32 v13, 2, v1
    v_cmp_eq_u32 vcc, 0, v13
    v_mov_b32 v12, s43
    v_mov_b32 v13, s44
    v_cndmask_b32 v12, v13, v12, vcc
    v_lshl_add_u32 v17, v11, 4, v12
    s_lshl_b32 s43, s57, 2
    s_sub_u32 s43, s43, 16
    v_add_u32 v11, s43, v1
    v_cmp_le_u32 vcc, 16, v1
    v_and_b32 v12, 1, v1
    s_add_u32 s44, s58, 240
    v_cndmask_b32 v17, v17, v11, vcc
    v_lshlrev_b32 v12, 3, v12
    v_add_u32 v12, s44, v12
    v_cmp_le_u32 vcc, 24, v1
    s_nop 1
    v_cndmask_b32 v17, v17, v12, vcc
    v_lshlrev_b32 v17, 7, v17
    s_waitcnt vmcnt(4) lgkmcnt(0)
    s_mov_b32 s32, s8
    s_and_b32 s33, s9, 0xffff
    s_mov_b32 s34, 2621440
    s_mov_b32 s35, 0x00020000
    s_barrier
    s_mov_b32 s45, 0
K2_R5:
    s_cmp_ge_u32 s49, 4
    s_cbranch_scc1 K2_R5_D
    s_and_b32 s44, s50, s51
    s_cbranch_scc0 K2_R5_G
    s_mov_b32 s44, 22618112
    buffer_load_dwordx2 v[136:137], v0, s[24:27], s44 offen sc1
    s_waitcnt vmcnt(0)
    v_xor_b32 v136, s10, v136
    v_xor_b32 v137, s11, v137
    v_or_b32 v136, v136, v137
    v_cmp_ne_u32 vcc, 0, v136
    s_add_u32 s45, s45, 1
    s_cmp_gt_u32 s45, 0x40000
    s_cselect_b32 s50, 0, vcc_lo
    s_and_b32 s44, s50, s51
    s_cbranch_scc0 K2_R5_G
    s_sleep 3
    s_branch K2_R5
K2_R5_G:
    s_add_u32 m0, s48, 0
    s_nop 0
    buffer_load_dwordx4 v90, s[24:27], s46 offen sc1 lds
    buffer_load_dword v91, s[24:27], s47 offen offset:1024 sc1 lds
    s_add_u32 s46, s46, 40960
    s_add_u32 s47, s47, 40960
    s_add_u32 m0, s48, 1280
    s_nop 0
    buffer_load_dwordx4 v90, s[24:27], s46 offen sc1 lds
    buffer_load_dword v91, s[24:27], s47 offen offset:1024 sc1 lds
    s_add_u32 s46, s46, 40960
    s_add_u32 s47, s47, 40960
    s_add_u32 m0, s48, 2560
    s_nop 0
    buffer_load_dwordx4 v90, s[24:27], s46 offen sc1 lds
    buffer_load_dword v91, s[24:27], s47 offen offset:1024 sc1 lds
    s_add_u32 s46, s46, 40960
    s_add_u32 s47, s47, 40960
    s_add_u32 m0, s48, 3840
    s_nop 0
    buffer_load_dwordx4 v90, s[24:27], s46 offen sc1 lds
    buffer_load_dword v91, s[24:27], s47 offen offset:1024 sc1 lds
    s_add_u32 s46, s46, 204800
    s_add_u32 s47, s47, 204800
    s_add_u32 s48, s48, 10240
    s_add_u32 s49, s49, 1
    s_lshl_b32 s51, s51, 2
    s_branch K2_R5
K2_R5_D:
    s_waitcnt vmcnt(8)
    s_barrier
    s_cmp_lg_u32 s36, 4
    s_cbranch_scc1 K2_H1
    v_mov_b32 v18, s10
    v_mov_b32 v19, s11
    s_lshl_b32 s45, s61, 7
    s_add_u32 s45, s45, 22650880
    s_mov_b64 exec, 1
    buffer_store_dwordx2 v[18:19], v94, s[24:27], s45 offen sc1
    s_mov_b64 exec, -1
K2_H1:
    v_mov_b32 v20, -1
    v_mov_b32 v21, -1
    v_mov_b32 v22, -1
    v_mov_b32 v23, -1
    v_mov_b32 v24, -1
    v_mov_b32 v25, -1
    s_add_u32 s41, s52, 40960
    s_add_u32 s42, s53, 40960
    buffer_store_dwordx4 v[20:23], v88, s[24:27], s41 offen sc1
    s_mov_b32 exec_hi, 0
    buffer_store_dwordx2 v[24:25], v88, s[24:27], s42 offen offset:2048 sc1
    s_mov_b32 exec_hi, -1
    s_add_u32 s41, s52, 122880
    s_add_u32 s42, s53, 122880
    buffer_store_dwordx4 v[20:23], v88, s[24:27], s41 offen sc1
    s_mov_b32 exec_hi, 0
    buffer_store_dwordx2 v[24:25], v88, s[24:27], s42 offen offset:2048 sc1
    s_mov_b32 exec_hi, -1
    s_mov_b32 s45, 0
K2_R8:
    s_cmp_ge_u32 s49, 8
    s_cbranch_scc1 K2_R8_D
    s_and_b32 s44, s50, s51
    s_cbranch_scc0 K2_R8_G
    s_mov_b32 s44, 22618112
    buffer_load_dwordx2 v[136:137], v0, s[24:27], s44 offen sc1
    s_waitcnt vmcnt(0)
    v_xor_b32 v136, s10, v136
    v_xor_b32 v137, s11, v137
    v_or_b32 v136, v136, v137
    v_cmp_ne_u32 vcc, 0, v136
    s_add_u32 s45, s45, 1
    s_cmp_gt_u32 s45, 0x40000
    s_cselect_b32 s50, 0, vcc_lo
    s_and_b32 s44, s50, s51
    s_cbranch_scc0 K2_R8_G
    s_sleep 3
    s_branch K2_R8
K2_R8_G:
    s_add_u32 m0, s48, 0
    s_nop 0
    buffer_load_dwordx4 v90, s[24:27], s46 offen sc1 lds
    buffer_load_dword v91, s[24:27], s47 offen offset:1024 sc1 lds
    s_add_u32 s46, s46, 40960
    s_add_u32 s47, s47, 40960
    s_add_u32 m0, s48, 1280
    s_nop 0
    buffer_load_dwordx4 v90, s[24:27], s46 offen sc1 lds
    buffer_load_dword v91, s[24:27], s47 offen offset:1024 sc1 lds
    s_add_u32 s46, s46, 40960
    s_add_u32 s47, s47, 40960
    s_add_u32 m0, s48, 2560
    s_nop 0
    buffer_load_dwordx4 v90, s[24:27], s46 offen sc1 lds
    buffer_load_dword v91, s[24:27], s47 offen offset:1024 sc1 lds
    s_add_u32 s46, s46, 40960
    s_add_u32 s47, s47, 40960
    s_add_u32 m0, s48, 3840
    s_nop 0
    buffer_load_dwordx4 v90, s[24:27], s46 offen sc1 lds
    buffer_load_dword v91, s[24:27], s47 offen offset:1024 sc1 lds
    s_add_u32 s46, s46, 204800
    s_add_u32 s47, s47, 204800
    s_add_u32 s48, s48, 10240
    s_add_u32 s49, s49, 1
    s_lshl_b32 s51, s51, 2
    s_branch K2_R8
K2_R8_D:
    s_mov_b32 s45, 0
K2_PF2:
    s_mov_b32 s44, 22650880
    buffer_load_dwordx2 v[136:137], v17, s[24:27], s44 offen sc1
K2_PF2_C:
    s_waitcnt vmcnt(0)
    v_xor_b32 v136, s10, v136
    v_xor_b32 v137, s11, v137
    v_or_b32 v136, v136, v137
    v_cmp_ne_u32 vcc, 0, v136
    s_add_u32 s45, s45, 1
    s_cmp_eq_u64 vcc, 0
    s_cbranch_scc1 K2_PF2_D
    s_sleep 8
    s_cmp_lt_u32 s45, 0x40000
    s_cbranch_scc1 K2_PF2
K2_PF2_D:
    s_add_u32 s44, s73, 0
    buffer_load_dwordx4 v[96:99], v88, s[24:27], s44 offen sc1
    s_add_u32 s45, s44, s60
    s_mov_b32 exec_hi, 0
    buffer_load_dwordx2 v[100:101], v88, s[24:27], s45 offen sc1
    s_mov_b32 exec_hi, -1
    s_add_u32 s44, s73, 2621440
    buffer_load_dwordx4 v[104:107], v88, s[24:27], s44 offen sc1
    s_add_u32 s45, s44, s60
    buffer_load_dwordx2 v[102:103], v88, s[24:27], s45 offen sc1
    s_add_u32 s44, s73, 2580480
    buffer_load_dwordx4 v[108:111], v88, s[24:27], s44 offen sc1
    s_add_u32 s45, s44, s60
    buffer_load_dwordx2 v[112:113], v88, s[24:27], s45 offen sc1
    s_mov_b64 exec, s[62:63]
    s_add_u32 s44, s74, 5242880
    buffer_load_dwordx4 v[116:119], v2, s[24:27], s44 offen sc1
    s_add_u32 s44, s74, 5263360
    buffer_load_dwordx4 v[120:123], v2, s[24:27], s44 offen sc1
    s_add_u32 s44, s74, 5222400
    buffer_load_dwordx4 v[124:127], v2, s[24:27], s44 offen sc1
    s_mov_b64 exec, -1
    s_lshl_b32 s44, s57, 7
    s_add_u32 s44, s44, 22609920
    v_lshlrev_b32 v11, 2, v92
    buffer_load_dword v114, v11, s[24:27], s44 offen sc1
    s_mov_b32 s68, 0
K2_LA:
    s_waitcnt vmcnt(0)
    v_mfma_f32_32x32x16_bf16 v[40:55], v[104:107], v[96:99], v[144:159]
    v_mfma_f32_32x32x16_bf16 v[56:71], v[108:111], v[96:99], v[160:175]
    v_mfma_f32_32x32x8_bf16 v[40:55], v[102:103], v[100:101], v[40:55]
    v_mfma_f32_32x32x8_bf16 v[56:71], v[112:113], v[100:101], v[56:71]
    s_nop 11
    v_max3_f32 v12, v40, v41, v42
    v_max3_f32 v13, v43, v44, v45
    v_max3_f32 v12, v12, v46, v47
    v_max3_f32 v13, v13, v48, v49
    v_max3_f32 v12, v12, v50, v51
    v_max3_f32 v13, v13, v52, v53
    v_max3_f32 v12, v12, v54, v55
    v_max3_f32 v13, v13, v64, v65
    v_max3_f32 v12, v12, v66, v67
    v_max3_f32 v13, v13, v68, v69
    v_max3_f32 v12, v12, v70, v71
    v_max_f32 v12, v12, v13
    v_mov_b32 v13, v12
    s_nop 1
    v_permlane32_swap_b32 v12, v13
    s_nop 1
    v_max_f32 v12, v12, v13
    v_pk_add_f32 v[40:41], v[40:41], v[12:13] op_sel_hi:[1,0] neg_lo:[0,1] neg_hi:[0,1]
    v_pk_add_f32 v[42:43], v[42:43], v[12:13] op_sel_hi:[1,0] neg_lo:[0,1] neg_hi:[0,1]
    v_pk_add_f32 v[44:45], v[44:45], v[12:13] op_sel_hi:[1,0] neg_lo:[0,1] neg_hi:[0,1]
    v_pk_add_f32 v[46:47], v[46:47], v[12:13] op_sel_hi:[1,0] neg_lo:[0,1] neg_hi:[0,1]
    v_pk_add_f32 v[48:49], v[48:49], v[12:13] op_sel_hi:[1,0] neg_lo:[0,1] neg_hi:[0,1]
    v_pk_add_f32 v[50:51], v[50:51], v[12:13] op_sel_hi:[1,0] neg_lo:[0,1] neg_hi:[0,1]
    v_pk_add_f32 v[52:53], v[52:53], v[12:13] op_sel_hi:[1,0] neg_lo:[0,1] neg_hi:[0,1]
    v_pk_add_f32 v[54:55], v[54:55], v[12:13] op_sel_hi:[1,0] neg_lo:[0,1] neg_hi:[0,1]
    v_pk_add_f32 v[64:65], v[64:65], v[12:13] op_sel_hi:[1,0] neg_lo:[0,1] neg_hi:[0,1]
    v_pk_add_f32 v[66:67], v[66:67], v[12:13] op_sel_hi:[1,0] neg_lo:[0,1] neg_hi:[0,1]
    v_pk_add_f32 v[68:69], v[68:69], v[12:13] op_sel_hi:[1,0] neg_lo:[0,1] neg_hi:[0,1]
    v_pk_add_f32 v[70:71], v[70:71], v[12:13] op_sel_hi:[1,0] neg_lo:[0,1] neg_hi:[0,1]
    v_exp_f32 v40, v40
    v_exp_f32 v41, v41
    v_exp_f32 v42, v42
    v_exp_f32 v43, v43
    v_exp_f32 v44, v44
    v_exp_f32 v45, v45
    v_exp_f32 v46, v46
    v_exp_f32 v47, v47
    v_exp_f32 v48, v48
    v_exp_f32 v49, v49
    v_exp_f32 v50, v50
    v_exp_f32 v51, v51
    v_exp_f32 v52, v52
    v_exp_f32 v53, v53
    v_exp_f32 v54, v54
    v_exp_f32 v55, v55
    v_exp_f32 v64, v64
    v_exp_f32 v65, v65
    v_exp_f32 v66, v66
    v_exp_f32 v67, v67
    v_exp_f32 v68, v68
    v_exp_f32 v69, v69
    v_exp_f32 v70, v70
    v_exp_f32 v71, v71
    s_nop 0
    v_cvt_pk_bf16_f32 v20, v40, v41
    v_cvt_pk_bf16_f32 v21, v42, v43
    v_cvt_pk_bf16_f32 v22, v44, v45
    v_cvt_pk_bf16_f32 v23, v46, v47
    v_cvt_pk_bf16_f32 v24, v48, v49
    v_cvt_pk_bf16_f32 v25, v50, v51
    v_cvt_pk_bf16_f32 v26, v52, v53
    v_cvt_pk_bf16_f32 v27, v54, v55
    v_cvt_pk_bf16_f32 v28, v64, v65
    v_cvt_pk_bf16_f32 v29, v66, v67
    v_cvt_pk_bf16_f32 v30, v68, v69
    v_cvt_pk_bf16_f32 v31, v70, v71
    s_nop 1
    v_mfma_f32_32x32x16_bf16 v[72:87], v[116:119], v[20:23], 0
    v_mfma_f32_32x32x16_bf16 v[72:87], v[120:123], v[24:27], v[72:87]
    v_mfma_f32_32x32x16_bf16 v[72:87], v[124:127], v[28:31], v[72:87]
    s_nop 11
    v_rcp_f32 v12, v84
    s_nop 0
    v_mul_f32 v12, v12, v114
    v_pk_mul_f32 v[72:73], v[72:73], v[12:13] op_sel_hi:[1,0]
    v_pk_mul_f32 v[74:75], v[74:75], v[12:13] op_sel_hi:[1,0]
    v_pk_mul_f32 v[76:77], v[76:77], v[12:13] op_sel_hi:[1,0]
    v_pk_mul_f32 v[78:79], v[78:79], v[12:13] op_sel_hi:[1,0]
    v_pk_mul_f32 v[80:81], v[80:81], v[12:13] op_sel_hi:[1,0]
    v_pk_mul_f32 v[82:83], v[82:83], v[12:13] op_sel_hi:[1,0]
    v_cvt_pk_bf16_f32 v32, v72, v73
    v_cvt_pk_bf16_f32 v33, v74, v75
    v_cvt_pk_bf16_f32 v34, v76, v77
    v_cvt_pk_bf16_f32 v35, v78, v79
    v_cvt_pk_bf16_f32 v36, v80, v81
    v_cvt_pk_bf16_f32 v37, v82, v83
    s_add_u32 s41, s52, 0
    s_add_u32 s42, s53, 0
    buffer_store_dwordx4 v[32:35], v88, s[24:27], s41 offen sc1
    s_mov_b32 exec_hi, 0
    buffer_store_dwordx2 v[36:37], v88, s[24:27], s42 offen offset:2048 sc1
    s_mov_b32 exec_hi, -1
    s_cmp_lg_u32 s68, 0
    s_cbranch_scc1 K2_LA2
    s_add_u32 s44, s73, 40960
    buffer_load_dwordx4 v[96:99], v88, s[24:27], s44 offen sc1
    s_add_u32 s45, s44, s60
    s_mov_b32 exec_hi, 0
    buffer_load_dwordx2 v[100:101], v88, s[24:27], s45 offen sc1
    s_mov_b32 exec_hi, -1
    s_add_u32 s44, s73, 2662400
    buffer_load_dwordx4 v[104:107], v88, s[24:27], s44 offen sc1
    s_add_u32 s45, s44, s60
    buffer_load_dwordx2 v[102:103], v88, s[24:27], s45 offen sc1
    s_add_u32 s44, s73, 2621440
    buffer_load_dwordx4 v[108:111], v88, s[24:27], s44 offen sc1
    s_add_u32 s45, s44, s60
    buffer_load_dwordx2 v[112:113], v88, s[24:27], s45 offen sc1
    s_mov_b64 exec, s[62:63]
    s_add_u32 s44, s74, 5283840
    buffer_load_dwordx4 v[116:119], v2, s[24:27], s44 offen sc1
    s_add_u32 s44, s74, 5304320
    buffer_load_dwordx4 v[120:123], v2, s[24:27], s44 offen sc1
    s_add_u32 s44, s74, 5263360
    buffer_load_dwordx4 v[124:127], v2, s[24:27], s44 offen sc1
    s_mov_b64 exec, -1
    s_lshl_b32 s44, s57, 7
    s_add_u32 s44, s44, 22610048
    v_lshlrev_b32 v11, 2, v92
    buffer_load_dword v114, v11, s[24:27], s44 offen sc1
    s_barrier
    s_mov_b32 s68, 1
    s_add_u32 s52, s52, 81920
    s_add_u32 s53, s53, 81920
    s_cmp_lg_u32 s57, 0
    s_cbranch_scc1 K2_LA
    s_mov_b32 s72, -1
    s_and_b32 s64, s72, 0x00000000
    s_and_b32 s65, s72, 0x00000005
    v_cndmask_b32_e64 v168, v15, 0, s[64:65]
    s_and_b32 s64, s72, 0x00000000
    s_and_b32 s65, s72, 0x0000000a
    v_cndmask_b32_e64 v169, v15, 0, s[64:65]
    s_and_b32 s64, s72, 0x00000001
    s_and_b32 s65, s72, 0x00000015
    v_cndmask_b32_e64 v170, v15, 0, s[64:65]
    s_and_b32 s64, s72, 0x00000002
    s_and_b32 s65, s72, 0x0000002a
    v_cndmask_b32_e64 v171, v15, 0, s[64:65]
    s_and_b32 s64, s72, 0x00000055
    s_and_b32 s65, s72, 0x00000555
    v_cndmask_b32_e64 v172, v15, 0, s[64:65]
    s_and_b32 s64, s72, 0x000000aa
    s_and_b32 s65, s72, 0x00000aaa
    v_cndmask_b32_e64 v173, v15, 0, s[64:65]
    s_and_b32 s64, s72, 0x00000155
    s_and_b32 s65, s72, 0x00001555
    v_cndmask_b32_e64 v174, v15, 0, s[64:65]
    s_and_b32 s64, s72, 0x000002aa
    s_and_b32 s65, s72, 0x00002aaa
    v_cndmask_b32_e64 v175, v15, 0, s[64:65]
    s_branch K2_LA
K2_LA2:
    v_mov_b32 v90, s10
    v_mov_b32 v91, s11
    s_lshl_b32 s41, s57, 11
    s_lshl_b32 s42, s56, 7
    s_add_u32 s41, s41, s42
    s_add_u32 s41, s41, 22683648
    s_waitcnt vmcnt(0)
    s_mov_b64 exec, 1
    buffer_store_dwordx2 v[90:91], v94, s[24:27], s41 offen sc1
    s_mov_b64 exec, -1
    s_setprio 0
    v_mov_b32 v6, v88
    s_and_b32 s46, s36, 3
    v_and_b32 v5, 15, v1
    v_lshrrev_b32 v4, 4, v1
    v_lshlrev_b32 v5, 4, v5
    v_lshl_add_u32 v4, v4, 9, v5
    v_add_u32 v7, 4096, v4
    v_add_u32 v8, 8192, v4
    s_mul_i32 s41, s56, 163840
    s_mul_i32 s42, s46, 10240
    s_add_u32 s41, s41, s42
    s_add_u32 s41, s41, 15728640
    s_add_u32 s42, s46, 0
    s_and_b32 s42, s42, 3
    s_and_b32 s4, s42, 1
    s_lshl_b32 s4, s4, 8
    s_lshr_b32 s42, s42, 1
    s_mul_i32 s42, s42, 81920
    s_add_u32 s4, s4, s42
    s_add_u32 s4, s4, s41
    s_add_u32 s42, s46, 1
    s_and_b32 s42, s42, 3
    s_and_b32 s5, s42, 1
    s_lshl_b32 s5, s5, 8
    s_lshr_b32 s42, s42, 1
    s_mul_i32 s42, s42, 81920
    s_add_u32 s5, s5, s42
    s_add_u32 s5, s5, s41
    s_add_u32 s42, s46, 2
    s_and_b32 s42, s42, 3
    s_and_b32 s6, s42, 1
    s_lshl_b32 s6, s6, 8
    s_lshr_b32 s42, s42, 1
    s_mul_i32 s42, s42, 81920
    s_add_u32 s6, s6, s42
    s_add_u32 s6, s6, s41
    s_add_u32 s42, s46, 3
    s_and_b32 s42, s42, 3
    s_and_b32 s7, s42, 1
    s_lshl_b32 s7, s7, 8
    s_lshr_b32 s42, s42, 1
    s_mul_i32 s42, s42, 81920
    s_add_u32 s7, s7, s42
    s_add_u32 s7, s7, s41
    s_mul_i32 s47, s58, 40
    s_mul_i32 s42, s46, 5
    s_add_u32 s47, s47, s42
    s_mul_i32 s47, s47, 5120
    s_add_u32 s47, s47, 20971520
    s_mov_b32 s48, 0
K2_OPL:
    buffer_load_dwordx4 v[16:19], v6, s[24:27], s47 offen offset:0 sc1
    buffer_load_dwordx4 v[20:23], v6, s[24:27], s47 offen offset:1024 sc1
    buffer_load_dwordx4 v[24:27], v6, s[24:27], s47 offen offset:2048 sc1
    buffer_load_dwordx4 v[28:31], v6, s[24:27], s47 offen offset:3072 sc1
    s_add_u32 s47, s47, 4096
    buffer_load_dwordx4 v[32:35], v6, s[24:27], s47 offen sc1
    s_add_u32 s47, s47, 1024
    buffer_load_dwordx4 v[36:39], v6, s[24:27], s47 offen offset:0 sc1
    buffer_load_dwordx4 v[40:43], v6, s[24:27], s47 offen offset:1024 sc1
    buffer_load_dwordx4 v[44:47], v6, s[24:27], s47 offen offset:2048 sc1
    buffer_load_dwordx4 v[48:51], v6, s[24:27], s47 offen offset:3072 sc1
    s_add_u32 s47, s47, 4096
    buffer_load_dwordx4 v[52:55], v6, s[24:27], s47 offen sc1
    s_add_u32 s47, s47, 1024
    buffer_load_dwordx4 v[56:59], v6, s[24:27], s47 offen offset:0 sc1
    buffer_load_dwordx4 v[60:63], v6, s[24:27], s47 offen offset:1024 sc1
    buffer_load_dwordx4 v[64:67], v6, s[24:27], s47 offen offset:2048 sc1
    buffer_load_dwordx4 v[68:71], v6, s[24:27], s47 offen offset:3072 sc1
    s_add_u32 s47, s47, 4096
    buffer_load_dwordx4 v[72:75], v6, s[24:27], s47 offen sc1
    s_add_u32 s47, s47, 1024
    buffer_load_dwordx4 v[76:79], v6, s[24:27], s47 offen offset:0 sc1
    buffer_load_dwordx4 v[80:83], v6, s[24:27], s47 offen offset:1024 sc1
    buffer_load_dwordx4 v[84:87], v6, s[24:27], s47 offen offset:2048 sc1
    buffer_load_dwordx4 v[88:91], v6, s[24:27], s47 offen offset:3072 sc1
    s_add_u32 s47, s47, 4096
    buffer_load_dwordx4 v[92:95], v6, s[24:27], s47 offen sc1
    s_add_u32 s47, s47, 1024
    s_mov_b32 s49, 0
    s_cmp_eq_u32 s48, 0
    s_cbranch_scc1 K2_P3
    s_barrier
    s_branch K2_NOB
K2_P3:
    v_and_b32 v9, 7, v1
    v_lshlrev_b32 v9, 7, v9
    s_lshl_b32 s41, s56, 12
    s_lshl_b32 s42, s46, 10
    s_add_u32 s41, s41, s42
    s_add_u32 s41, s41, 22683648
K2_P3L:
    buffer_load_dwordx2 v[10:11], v9, s[24:27], s41 offen sc1
    s_waitcnt vmcnt(0)
    v_xor_b32 v10, s10, v10
    v_xor_b32 v11, s11, v11
    v_or_b32 v10, v10, v11
    v_cmp_ne_u32 vcc, 0, v10
    s_add_u32 s49, s49, 1
    s_cmp_eq_u64 vcc, 0
    s_cbranch_scc1 K2_P3D
    s_sleep 8
    s_cmp_lt_u32 s49, 0x40000
    s_cbranch_scc1 K2_P3L
K2_P3D:
K2_NOB:
    buffer_load_dwordx4 v[96:99], v4, s[24:27], s4 offen offset:0 sc1
    buffer_load_dwordx4 v[100:103], v4, s[24:27], s5 offen offset:0 sc1
    buffer_load_dwordx4 v[104:107], v4, s[24:27], s6 offen offset:0 sc1
    buffer_load_dwordx4 v[108:111], v4, s[24:27], s7 offen offset:0 sc1
    buffer_load_dwordx4 v[112:115], v4, s[24:27], s4 offen offset:2048 sc1
    buffer_load_dwordx4 v[116:119], v4, s[24:27], s5 offen offset:2048 sc1
    buffer_load_dwordx4 v[120:123], v4, s[24:27], s6 offen offset:2048 sc1
    buffer_load_dwordx4 v[124:127], v4, s[24:27], s7 offen offset:2048 sc1
    buffer_load_dwordx4 v[128:131], v7, s[24:27], s4 offen offset:0 sc1
    buffer_load_dwordx4 v[132:135], v7, s[24:27], s5 offen offset:0 sc1
    buffer_load_dwordx4 v[136:139], v7, s[24:27], s6 offen offset:0 sc1
    buffer_load_dwordx4 v[140:143], v7, s[24:27], s7 offen offset:0 sc1
    buffer_load_dwordx4 v[144:147], v7, s[24:27], s4 offen offset:2048 sc1
    buffer_load_dwordx4 v[148:151], v7, s[24:27], s5 offen offset:2048 sc1
    buffer_load_dwordx4 v[152:155], v7, s[24:27], s6 offen offset:2048 sc1
    buffer_load_dwordx4 v[156:159], v7, s[24:27], s7 offen offset:2048 sc1
    buffer_load_dwordx4 v[160:163], v8, s[24:27], s4 offen offset:0 sc1
    buffer_load_dwordx4 v[164:167], v8, s[24:27], s5 offen offset:0 sc1
    buffer_load_dwordx4 v[168:171], v8, s[24:27], s6 offen offset:0 sc1
    buffer_load_dwordx4 v[172:175], v8, s[24:27], s7 offen offset:0 sc1
    s_waitcnt vmcnt(16)
    s_cmp_eq_u32 s48, 0
    s_cbranch_scc1 K2_Z0
K2_CK0:
    v_max3_u32 v5, v96, v97, v98
    v_max3_u32 v9, v99, v100, v101
    v_max3_u32 v5, v5, v102, v103
    v_max3_u32 v9, v9, v104, v105
    v_max3_u32 v5, v5, v106, v107
    v_max3_u32 v9, v9, v108, v109
    v_max3_u32 v5, v5, v110, v111
    v_max_u32 v5, v5, v9
    v_cmp_eq_u32 vcc, -1, v5
    s_add_u32 s49, s49, 1
    s_cmp_eq_u64 vcc, 0
    s_cbranch_scc1 K2_OK0
    s_cmp_gt_u32 s49, 0x40000
    s_cbranch_scc1 K2_OK0
    s_sleep 1
    buffer_load_dwordx4 v[96:99], v4, s[24:27], s4 offen offset:0 sc1
    buffer_load_dwordx4 v[100:103], v4, s[24:27], s5 offen offset:0 sc1
    buffer_load_dwordx4 v[104:107], v4, s[24:27], s6 offen offset:0 sc1
    buffer_load_dwordx4 v[108:111], v4, s[24:27], s7 offen offset:0 sc1
    buffer_load_dwordx4 v[112:115], v4, s[24:27], s4 offen offset:2048 sc1
    buffer_load_dwordx4 v[116:119], v4, s[24:27], s5 offen offset:2048 sc1
    buffer_load_dwordx4 v[120:123], v4, s[24:27], s6 offen offset:2048 sc1
    buffer_load_dwordx4 v[124:127], v4, s[24:27], s7 offen offset:2048 sc1
    buffer_load_dwordx4 v[128:131], v7, s[24:27], s4 offen offset:0 sc1
    buffer_load_dwordx4 v[132:135], v7, s[24:27], s5 offen offset:0 sc1
    buffer_load_dwordx4 v[136:139], v7, s[24:27], s6 offen offset:0 sc1
    buffer_load_dwordx4 v[140:143], v7, s[24:27], s7 offen offset:0 sc1
    buffer_load_dwordx4 v[144:147], v7, s[24:27], s4 offen offset:2048 sc1
    buffer_load_dwordx4 v[148:151], v7, s[24:27], s5 offen offset:2048 sc1
    buffer_load_dwordx4 v[152:155], v7, s[24:27], s6 offen offset:2048 sc1
    buffer_load_dwordx4 v[156:159], v7, s[24:27], s7 offen offset:2048 sc1
    buffer_load_dwordx4 v[160:163], v8, s[24:27], s4 offen offset:0 sc1
    buffer_load_dwordx4 v[164:167], v8, s[24:27], s5 offen offset:0 sc1
    buffer_load_dwordx4 v[168:171], v8, s[24:27], s6 offen offset:0 sc1
    buffer_load_dwordx4 v[172:175], v8, s[24:27], s7 offen offset:0 sc1
    s_waitcnt vmcnt(0)
    s_branch K2_CK0
K2_Z0:
    v_mfma_f32_16x16x32_bf16 v[176:179], v[16:19], v[96:99], 0
    v_mfma_f32_16x16x32_bf16 v[180:183], v[20:23], v[96:99], 0
    v_mfma_f32_16x16x32_bf16 v[184:187], v[24:27], v[96:99], 0
    v_mfma_f32_16x16x32_bf16 v[188:191], v[28:31], v[96:99], 0
    v_mfma_f32_16x16x32_bf16 v[192:195], v[32:35], v[96:99], 0
    v_mfma_f32_16x16x32_bf16 v[196:199], v[16:19], v[100:103], 0
    v_mfma_f32_16x16x32_bf16 v[200:203], v[20:23], v[100:103], 0
    v_mfma_f32_16x16x32_bf16 v[204:207], v[24:27], v[100:103], 0
    v_mfma_f32_16x16x32_bf16 v[208:211], v[28:31], v[100:103], 0
    v_mfma_f32_16x16x32_bf16 v[212:215], v[32:35], v[100:103], 0
    v_mfma_f32_16x16x32_bf16 v[216:219], v[16:19], v[104:107], 0
    v_mfma_f32_16x16x32_bf16 v[220:223], v[20:23], v[104:107], 0
    v_mfma_f32_16x16x32_bf16 v[224:227], v[24:27], v[104:107], 0
    v_mfma_f32_16x16x32_bf16 v[228:231], v[28:31], v[104:107], 0
    v_mfma_f32_16x16x32_bf16 v[232:235], v[32:35], v[104:107], 0
    v_mfma_f32_16x16x32_bf16 v[236:239], v[16:19], v[108:111], 0
    v_mfma_f32_16x16x32_bf16 v[240:243], v[20:23], v[108:111], 0
    v_mfma_f32_16x16x32_bf16 v[244:247], v[24:27], v[108:111], 0
    v_mfma_f32_16x16x32_bf16 v[248:251], v[28:31], v[108:111], 0
    v_mfma_f32_16x16x32_bf16 v[252:255], v[32:35], v[108:111], 0
    s_branch K2_Z1
K2_OK0:
    v_mfma_f32_16x16x32_bf16 v[176:179], v[16:19], v[96:99], v[176:179]
    v_mfma_f32_16x16x32_bf16 v[180:183], v[20:23], v[96:99], v[180:183]
    v_mfma_f32_16x16x32_bf16 v[184:187], v[24:27], v[96:99], v[184:187]
    v_mfma_f32_16x16x32_bf16 v[188:191], v[28:31], v[96:99], v[188:191]
    v_mfma_f32_16x16x32_bf16 v[192:195], v[32:35], v[96:99], v[192:195]
    v_mfma_f32_16x16x32_bf16 v[196:199], v[16:19], v[100:103], v[196:199]
    v_mfma_f32_16x16x32_bf16 v[200:203], v[20:23], v[100:103], v[200:203]
    v_mfma_f32_16x16x32_bf16 v[204:207], v[24:27], v[100:103], v[204:207]
    v_mfma_f32_16x16x32_bf16 v[208:211], v[28:31], v[100:103], v[208:211]
    v_mfma_f32_16x16x32_bf16 v[212:215], v[32:35], v[100:103], v[212:215]
    v_mfma_f32_16x16x32_bf16 v[216:219], v[16:19], v[104:107], v[216:219]
    v_mfma_f32_16x16x32_bf16 v[220:223], v[20:23], v[104:107], v[220:223]
    v_mfma_f32_16x16x32_bf16 v[224:227], v[24:27], v[104:107], v[224:227]
    v_mfma_f32_16x16x32_bf16 v[228:231], v[28:31], v[104:107], v[228:231]
    v_mfma_f32_16x16x32_bf16 v[232:235], v[32:35], v[104:107], v[232:235]
    v_mfma_f32_16x16x32_bf16 v[236:239], v[16:19], v[108:111], v[236:239]
    v_mfma_f32_16x16x32_bf16 v[240:243], v[20:23], v[108:111], v[240:243]
    v_mfma_f32_16x16x32_bf16 v[244:247], v[24:27], v[108:111], v[244:247]
    v_mfma_f32_16x16x32_bf16 v[248:251], v[28:31], v[108:111], v[248:251]
    v_mfma_f32_16x16x32_bf16 v[252:255], v[32:35], v[108:111], v[252:255]
K2_Z1:
    buffer_load_dwordx4 v[16:19], v6, s[24:27], s47 offen offset:0 sc1
    buffer_load_dwordx4 v[20:23], v6, s[24:27], s47 offen offset:1024 sc1
    buffer_load_dwordx4 v[24:27], v6, s[24:27], s47 offen offset:2048 sc1
    buffer_load_dwordx4 v[28:31], v6, s[24:27], s47 offen offset:3072 sc1
    s_add_u32 s47, s47, 4096
    buffer_load_dwordx4 v[32:35], v6, s[24:27], s47 offen sc1
    s_add_u32 s47, s47, 1024
    s_waitcnt vmcnt(17)
    s_cmp_eq_u32 s48, 0
    s_cbranch_scc1 K2_OK1
K2_CK1:
    v_max3_u32 v5, v112, v113, v114
    v_max3_u32 v9, v115, v116, v117
    v_max3_u32 v5, v5, v118, v119
    v_max3_u32 v9, v9, v120, v121
    v_max3_u32 v5, v5, v122, v123
    v_max3_u32 v9, v9, v124, v125
    v_max3_u32 v5, v5, v126, v127
    v_max_u32 v5, v5, v9
    v_cmp_eq_u32 vcc, -1, v5
    s_add_u32 s49, s49, 1
    s_cmp_eq_u64 vcc, 0
    s_cbranch_scc1 K2_OK1
    s_cmp_gt_u32 s49, 0x40000
    s_cbranch_scc1 K2_OK1
    s_sleep 1
    buffer_load_dwordx4 v[112:115], v4, s[24:27], s4 offen offset:2048 sc1
    buffer_load_dwordx4 v[116:119], v4, s[24:27], s5 offen offset:2048 sc1
    buffer_load_dwordx4 v[120:123], v4, s[24:27], s6 offen offset:2048 sc1
    buffer_load_dwordx4 v[124:127], v4, s[24:27], s7 offen offset:2048 sc1
    buffer_load_dwordx4 v[128:131], v7, s[24:27], s4 offen offset:0 sc1
    buffer_load_dwordx4 v[132:135], v7, s[24:27], s5 offen offset:0 sc1
    buffer_load_dwordx4 v[136:139], v7, s[24:27], s6 offen offset:0 sc1
    buffer_load_dwordx4 v[140:143], v7, s[24:27], s7 offen offset:0 sc1
    buffer_load_dwordx4 v[144:147], v7, s[24:27], s4 offen offset:2048 sc1
    buffer_load_dwordx4 v[148:151], v7, s[24:27], s5 offen offset:2048 sc1
    buffer_load_dwordx4 v[152:155], v7, s[24:27], s6 offen offset:2048 sc1
    buffer_load_dwordx4 v[156:159], v7, s[24:27], s7 offen offset:2048 sc1
    buffer_load_dwordx4 v[160:163], v8, s[24:27], s4 offen offset:0 sc1
    buffer_load_dwordx4 v[164:167], v8, s[24:27], s5 offen offset:0 sc1
    buffer_load_dwordx4 v[168:171], v8, s[24:27], s6 offen offset:0 sc1
    buffer_load_dwordx4 v[172:175], v8, s[24:27], s7 offen offset:0 sc1
    s_waitcnt vmcnt(0)
    s_branch K2_CK1
K2_OK1:
    v_mfma_f32_16x16x32_bf16 v[176:179], v[36:39], v[112:115], v[176:179]
    v_mfma_f32_16x16x32_bf16 v[180:183], v[40:43], v[112:115], v[180:183]
    v_mfma_f32_16x16x32_bf16 v[184:187], v[44:47], v[112:115], v[184:187]
    v_mfma_f32_16x16x32_bf16 v[188:191], v[48:51], v[112:115], v[188:191]
    v_mfma_f32_16x16x32_bf16 v[192:195], v[52:55], v[112:115], v[192:195]
    v_mfma_f32_16x16x32_bf16 v[196:199], v[36:39], v[116:119], v[196:199]
    v_mfma_f32_16x16x32_bf16 v[200:203], v[40:43], v[116:119], v[200:203]
    v_mfma_f32_16x16x32_bf16 v[204:207], v[44:47], v[116:119], v[204:207]
    v_mfma_f32_16x16x32_bf16 v[208:211], v[48:51], v[116:119], v[208:211]
    v_mfma_f32_16x16x32_bf16 v[212:215], v[52:55], v[116:119], v[212:215]
    v_mfma_f32_16x16x32_bf16 v[216:219], v[36:39], v[120:123], v[216:219]
    v_mfma_f32_16x16x32_bf16 v[220:223], v[40:43], v[120:123], v[220:223]
    v_mfma_f32_16x16x32_bf16 v[224:227], v[44:47], v[120:123], v[224:227]
    v_mfma_f32_16x16x32_bf16 v[228:231], v[48:51], v[120:123], v[228:231]
    v_mfma_f32_16x16x32_bf16 v[232:235], v[52:55], v[120:123], v[232:235]
    v_mfma_f32_16x16x32_bf16 v[236:239], v[36:39], v[124:127], v[236:239]
    v_mfma_f32_16x16x32_bf16 v[240:243], v[40:43], v[124:127], v[240:243]
    v_mfma_f32_16x16x32_bf16 v[244:247], v[44:47], v[124:127], v[244:247]
    v_mfma_f32_16x16x32_bf16 v[248:251], v[48:51], v[124:127], v[248:251]
    v_mfma_f32_16x16x32_bf16 v[252:255], v[52:55], v[124:127], v[252:255]
    s_waitcnt vmcnt(13)
    s_cmp_eq_u32 s48, 0
    s_cbranch_scc1 K2_OK2
K2_CK2:
    v_max3_u32 v5, v128, v129, v130
    v_max3_u32 v9, v131, v132, v133
    v_max3_u32 v5, v5, v134, v135
    v_max3_u32 v9, v9, v136, v137
    v_max3_u32 v5, v5, v138, v139
    v_max3_u32 v9, v9, v140, v141
    v_max3_u32 v5, v5, v142, v143
    v_max_u32 v5, v5, v9
    v_cmp_eq_u32 vcc, -1, v5
    s_add_u32 s49, s49, 1
    s_cmp_eq_u64 vcc, 0
    s_cbranch_scc1 K2_OK2
    s_cmp_gt_u32 s49, 0x40000
    s_cbranch_scc1 K2_OK2
    s_sleep 1
    buffer_load_dwordx4 v[128:131], v7, s[24:27], s4 offen offset:0 sc1
    buffer_load_dwordx4 v[132:135], v7, s[24:27], s5 offen offset:0 sc1
    buffer_load_dwordx4 v[136:139], v7, s[24:27], s6 offen offset:0 sc1
    buffer_load_dwordx4 v[140:143], v7, s[24:27], s7 offen offset:0 sc1
    buffer_load_dwordx4 v[144:147], v7, s[24:27], s4 offen offset:2048 sc1
    buffer_load_dwordx4 v[148:151], v7, s[24:27], s5 offen offset:2048 sc1
    buffer_load_dwordx4 v[152:155], v7, s[24:27], s6 offen offset:2048 sc1
    buffer_load_dwordx4 v[156:159], v7, s[24:27], s7 offen offset:2048 sc1
    buffer_load_dwordx4 v[160:163], v8, s[24:27], s4 offen offset:0 sc1
    buffer_load_dwordx4 v[164:167], v8, s[24:27], s5 offen offset:0 sc1
    buffer_load_dwordx4 v[168:171], v8, s[24:27], s6 offen offset:0 sc1
    buffer_load_dwordx4 v[172:175], v8, s[24:27], s7 offen offset:0 sc1
    s_waitcnt vmcnt(0)
    s_branch K2_CK2
K2_OK2:
    v_mfma_f32_16x16x32_bf16 v[176:179], v[56:59], v[128:131], v[176:179]
    v_mfma_f32_16x16x32_bf16 v[180:183], v[60:63], v[128:131], v[180:183]
    v_mfma_f32_16x16x32_bf16 v[184:187], v[64:67], v[128:131], v[184:187]
    v_mfma_f32_16x16x32_bf16 v[188:191], v[68:71], v[128:131], v[188:191]
    v_mfma_f32_16x16x32_bf16 v[192:195], v[72:75], v[128:131], v[192:195]
    v_mfma_f32_16x16x32_bf16 v[196:199], v[56:59], v[132:135], v[196:199]
    v_mfma_f32_16x16x32_bf16 v[200:203], v[60:63], v[132:135], v[200:203]
    v_mfma_f32_16x16x32_bf16 v[204:207], v[64:67], v[132:135], v[204:207]
    v_mfma_f32_16x16x32_bf16 v[208:211], v[68:71], v[132:135], v[208:211]
    v_mfma_f32_16x16x32_bf16 v[212:215], v[72:75], v[132:135], v[212:215]
    v_mfma_f32_16x16x32_bf16 v[216:219], v[56:59], v[136:139], v[216:219]
    v_mfma_f32_16x16x32_bf16 v[220:223], v[60:63], v[136:139], v[220:223]
    v_mfma_f32_16x16x32_bf16 v[224:227], v[64:67], v[136:139], v[224:227]
    v_mfma_f32_16x16x32_bf16 v[228:231], v[68:71], v[136:139], v[228:231]
    v_mfma_f32_16x16x32_bf16 v[232:235], v[72:75], v[136:139], v[232:235]
    v_mfma_f32_16x16x32_bf16 v[236:239], v[56:59], v[140:143], v[236:239]
    v_mfma_f32_16x16x32_bf16 v[240:243], v[60:63], v[140:143], v[240:243]
    v_mfma_f32_16x16x32_bf16 v[244:247], v[64:67], v[140:143], v[244:247]
    v_mfma_f32_16x16x32_bf16 v[248:251], v[68:71], v[140:143], v[248:251]
    v_mfma_f32_16x16x32_bf16 v[252:255], v[72:75], v[140:143], v[252:255]
    s_waitcnt vmcnt(9)
    s_cmp_eq_u32 s48, 0
    s_cbranch_scc1 K2_OK3
K2_CK3:
    v_max3_u32 v5, v144, v145, v146
    v_max3_u32 v9, v147, v148, v149
    v_max3_u32 v5, v5, v150, v151
    v_max3_u32 v9, v9, v152, v153
    v_max3_u32 v5, v5, v154, v155
    v_max3_u32 v9, v9, v156, v157
    v_max3_u32 v5, v5, v158, v159
    v_max_u32 v5, v5, v9
    v_cmp_eq_u32 vcc, -1, v5
    s_add_u32 s49, s49, 1
    s_cmp_eq_u64 vcc, 0
    s_cbranch_scc1 K2_OK3
    s_cmp_gt_u32 s49, 0x40000
    s_cbranch_scc1 K2_OK3
    s_sleep 1
    buffer_load_dwordx4 v[144:147], v7, s[24:27], s4 offen offset:2048 sc1
    buffer_load_dwordx4 v[148:151], v7, s[24:27], s5 offen offset:2048 sc1
    buffer_load_dwordx4 v[152:155], v7, s[24:27], s6 offen offset:2048 sc1
    buffer_load_dwordx4 v[156:159], v7, s[24:27], s7 offen offset:2048 sc1
    buffer_load_dwordx4 v[160:163], v8, s[24:27], s4 offen offset:0 sc1
    buffer_load_dwordx4 v[164:167], v8, s[24:27], s5 offen offset:0 sc1
    buffer_load_dwordx4 v[168:171], v8, s[24:27], s6 offen offset:0 sc1
    buffer_load_dwordx4 v[172:175], v8, s[24:27], s7 offen offset:0 sc1
    s_waitcnt vmcnt(0)
    s_branch K2_CK3
K2_OK3:
    v_mfma_f32_16x16x32_bf16 v[176:179], v[76:79], v[144:147], v[176:179]
    v_mfma_f32_16x16x32_bf16 v[180:183], v[80:83], v[144:147], v[180:183]
    v_mfma_f32_16x16x32_bf16 v[184:187], v[84:87], v[144:147], v[184:187]
    v_mfma_f32_16x16x32_bf16 v[188:191], v[88:91], v[144:147], v[188:191]
    v_mfma_f32_16x16x32_bf16 v[192:195], v[92:95], v[144:147], v[192:195]
    v_mfma_f32_16x16x32_bf16 v[196:199], v[76:79], v[148:151], v[196:199]
    v_mfma_f32_16x16x32_bf16 v[200:203], v[80:83], v[148:151], v[200:203]
    v_mfma_f32_16x16x32_bf16 v[204:207], v[84:87], v[148:151], v[204:207]
    v_mfma_f32_16x16x32_bf16 v[208:211], v[88:91], v[148:151], v[208:211]
    v_mfma_f32_16x16x32_bf16 v[212:215], v[92:95], v[148:151], v[212:215]
    v_mfma_f32_16x16x32_bf16 v[216:219], v[76:79], v[152:155], v[216:219]
    v_mfma_f32_16x16x32_bf16 v[220:223], v[80:83], v[152:155], v[220:223]
    v_mfma_f32_16x16x32_bf16 v[224:227], v[84:87], v[152:155], v[224:227]
    v_mfma_f32_16x16x32_bf16 v[228:231], v[88:91], v[152:155], v[228:231]
    v_mfma_f32_16x16x32_bf16 v[232:235], v[92:95], v[152:155], v[232:235]
    v_mfma_f32_16x16x32_bf16 v[236:239], v[76:79], v[156:159], v[236:239]
    v_mfma_f32_16x16x32_bf16 v[240:243], v[80:83], v[156:159], v[240:243]
    v_mfma_f32_16x16x32_bf16 v[244:247], v[84:87], v[156:159], v[244:247]
    v_mfma_f32_16x16x32_bf16 v[248:251], v[88:91], v[156:159], v[248:251]
    v_mfma_f32_16x16x32_bf16 v[252:255], v[92:95], v[156:159], v[252:255]
    s_waitcnt vmcnt(0)
    s_cmp_eq_u32 s48, 0
    s_cbranch_scc1 K2_OK4
K2_CK4:
    v_max3_u32 v5, v160, v161, v162
    v_max3_u32 v9, v163, v164, v165
    v_max3_u32 v5, v5, v166, v167
    v_max3_u32 v9, v9, v168, v169
    v_max3_u32 v5, v5, v170, v171
    v_max3_u32 v9, v9, v172, v173
    v_max3_u32 v5, v5, v174, v175
    v_max_u32 v5, v5, v9
    v_cmp_eq_u32 vcc, -1, v5
    s_add_u32 s49, s49, 1
    s_cmp_eq_u64 vcc, 0
    s_cbranch_scc1 K2_OK4
    s_cmp_gt_u32 s49, 0x40000
    s_cbranch_scc1 K2_OK4
    s_sleep 1
    buffer_load_dwordx4 v[160:163], v8, s[24:27], s4 offen offset:0 sc1
    buffer_load_dwordx4 v[164:167], v8, s[24:27], s5 offen offset:0 sc1
    buffer_load_dwordx4 v[168:171], v8, s[24:27], s6 offen offset:0 sc1
    buffer_load_dwordx4 v[172:175], v8, s[24:27], s7 offen offset:0 sc1
    s_waitcnt vmcnt(0)
    s_branch K2_CK4
K2_OK4:
    v_mfma_f32_16x16x32_bf16 v[196:199], v[16:19], v[164:167], v[196:199]
    v_mfma_f32_16x16x32_bf16 v[200:203], v[20:23], v[164:167], v[200:203]
    v_mfma_f32_16x16x32_bf16 v[204:207], v[24:27], v[164:167], v[204:207]
    v_mfma_f32_16x16x32_bf16 v[208:211], v[28:31], v[164:167], v[208:211]
    v_mfma_f32_16x16x32_bf16 v[212:215], v[32:35], v[164:167], v[212:215]
    v_mfma_f32_16x16x32_bf16 v[216:219], v[16:19], v[168:171], v[216:219]
    v_mfma_f32_16x16x32_bf16 v[220:223], v[20:23], v[168:171], v[220:223]
    v_mfma_f32_16x16x32_bf16 v[224:227], v[24:27], v[168:171], v[224:227]
    v_mfma_f32_16x16x32_bf16 v[228:231], v[28:31], v[168:171], v[228:231]
    v_mfma_f32_16x16x32_bf16 v[232:235], v[32:35], v[168:171], v[232:235]
    v_mfma_f32_16x16x32_bf16 v[236:239], v[16:19], v[172:175], v[236:239]
    v_mfma_f32_16x16x32_bf16 v[240:243], v[20:23], v[172:175], v[240:243]
    v_mfma_f32_16x16x32_bf16 v[244:247], v[24:27], v[172:175], v[244:247]
    v_mfma_f32_16x16x32_bf16 v[248:251], v[28:31], v[172:175], v[248:251]
    v_mfma_f32_16x16x32_bf16 v[252:255], v[32:35], v[172:175], v[252:255]
    v_mfma_f32_16x16x32_bf16 v[176:179], v[16:19], v[160:163], v[176:179]
    v_mfma_f32_16x16x32_bf16 v[180:183], v[20:23], v[160:163], v[180:183]
    v_mfma_f32_16x16x32_bf16 v[184:187], v[24:27], v[160:163], v[184:187]
    v_mfma_f32_16x16x32_bf16 v[188:191], v[28:31], v[160:163], v[188:191]
    v_mfma_f32_16x16x32_bf16 v[192:195], v[32:35], v[160:163], v[192:195]
    s_add_u32 s4, s4, 40960
    s_add_u32 s5, s5, 40960
    s_add_u32 s6, s6, 40960
    s_add_u32 s7, s7, 40960
    s_add_u32 s47, s47, 76800
    s_add_u32 s48, s48, 1
    s_cmp_lt_u32 s48, 2
    s_cbranch_scc1 K2_OPL
    s_add_u32 s41, s46, 1
    s_and_b32 s41, s41, 3
    s_mul_i32 s41, s41, 15360
    v_add_u32 v5, s41, v6
    ds_write_b128 v5, v[196:199] offset:0
    ds_write_b128 v5, v[200:203] offset:1024
    ds_write_b128 v5, v[204:207] offset:2048
    ds_write_b128 v5, v[208:211] offset:3072
    ds_write_b128 v5, v[212:215] offset:4096
    s_add_u32 s41, s46, 2
    s_and_b32 s41, s41, 3
    s_mul_i32 s41, s41, 15360
    v_add_u32 v5, s41, v6
    ds_write_b128 v5, v[216:219] offset:5120
    ds_write_b128 v5, v[220:223] offset:6144
    ds_write_b128 v5, v[224:227] offset:7168
    ds_write_b128 v5, v[228:231] offset:8192
    ds_write_b128 v5, v[232:235] offset:9216
    s_add_u32 s41, s46, 3
    s_and_b32 s41, s41, 3
    s_mul_i32 s41, s41, 15360
    v_add_u32 v5, s41, v6
    ds_write_b128 v5, v[236:239] offset:10240
    ds_write_b128 v5, v[240:243] offset:11264
    ds_write_b128 v5, v[244:247] offset:12288
    ds_write_b128 v5, v[248:251] offset:13312
    ds_write_b128 v5, v[252:255] offset:14336
    s_mul_i32 s41, s46, 15360
    v_add_u32 v5, s41, v6
    s_waitcnt lgkmcnt(0)
    s_barrier
    ds_read_b128 v[16:19], v5 offset:0
    ds_read_b128 v[20:23], v5 offset:1024
    ds_read_b128 v[24:27], v5 offset:2048
    ds_read_b128 v[28:31], v5 offset:3072
    ds_read_b128 v[32:35], v5 offset:4096
    ds_read_b128 v[36:39], v5 offset:5120
    ds_read_b128 v[40:43], v5 offset:6144
    ds_read_b128 v[44:47], v5 offset:7168
    ds_read_b128 v[48:51], v5 offset:8192
    ds_read_b128 v[52:55], v5 offset:9216
    ds_read_b128 v[56:59], v5 offset:10240
    ds_read_b128 v[60:63], v5 offset:11264
    ds_read_b128 v[64:67], v5 offset:12288
    ds_read_b128 v[68:71], v5 offset:13312
    ds_read_b128 v[72:75], v5 offset:14336
    v_and_b32 v4, 15, v1
    v_lshrrev_b32 v7, 4, v1
    v_mul_u32_u24 v4, 1280, v4
    v_mul_u32_u24 v7, 40, v7
    v_add_u32 v4, v4, v7
    s_lshl_b32 s41, s56, 2
    s_add_u32 s41, s41, s46
    s_mul_i32 s41, s41, 20480
    s_mul_i32 s42, s58, 160
    s_add_u32 s41, s41, s42
    s_waitcnt lgkmcnt(10)
    v_pk_add_f32 v[176:177], v[176:177], v[16:17]
    v_pk_add_f32 v[178:179], v[178:179], v[18:19]
    v_pk_add_f32 v[180:181], v[180:181], v[20:21]
    v_pk_add_f32 v[182:183], v[182:183], v[22:23]
    v_pk_add_f32 v[184:185], v[184:185], v[24:25]
    v_pk_add_f32 v[186:187], v[186:187], v[26:27]
    v_pk_add_f32 v[188:189], v[188:189], v[28:29]
    v_pk_add_f32 v[190:191], v[190:191], v[30:31]
    v_pk_add_f32 v[192:193], v[192:193], v[32:33]
    v_pk_add_f32 v[194:195], v[194:195], v[34:35]
    s_waitcnt lgkmcnt(5)
    v_pk_add_f32 v[176:177], v[176:177], v[36:37]
    v_pk_add_f32 v[178:179], v[178:179], v[38:39]
    v_pk_add_f32 v[180:181], v[180:181], v[40:41]
    v_pk_add_f32 v[182:183], v[182:183], v[42:43]
    v_pk_add_f32 v[184:185], v[184:185], v[44:45]
    v_pk_add_f32 v[186:187], v[186:187], v[46:47]
    v_pk_add_f32 v[188:189], v[188:189], v[48:49]
    v_pk_add_f32 v[190:191], v[190:191], v[50:51]
    v_pk_add_f32 v[192:193], v[192:193], v[52:53]
    v_pk_add_f32 v[194:195], v[194:195], v[54:55]
    s_waitcnt lgkmcnt(0)
    v_pk_add_f32 v[176:177], v[176:177], v[56:57]
    v_pk_add_f32 v[178:179], v[178:179], v[58:59]
    v_pk_add_f32 v[180:181], v[180:181], v[60:61]
    v_pk_add_f32 v[182:183], v[182:183], v[62:63]
    v_pk_add_f32 v[184:185], v[184:185], v[64:65]
    v_pk_add_f32 v[186:187], v[186:187], v[66:67]
    v_pk_add_f32 v[188:189], v[188:189], v[68:69]
    v_pk_add_f32 v[190:191], v[190:191], v[70:71]
    v_pk_add_f32 v[192:193], v[192:193], v[72:73]
    v_pk_add_f32 v[194:195], v[194:195], v[74:75]
    v_cvt_pk_bf16_f32 v96, v176, v177
    v_cvt_pk_bf16_f32 v97, v178, v179
    v_cvt_pk_bf16_f32 v98, v180, v181
    v_cvt_pk_bf16_f32 v99, v182, v183
    v_cvt_pk_bf16_f32 v100, v184, v185
    v_cvt_pk_bf16_f32 v101, v186, v187
    v_cvt_pk_bf16_f32 v102, v188, v189
    v_cvt_pk_bf16_f32 v103, v190, v191
    v_cvt_pk_bf16_f32 v104, v192, v193
    v_cvt_pk_bf16_f32 v105, v194, v195
    buffer_store_dwordx4 v[96:99], v4, s[32:35], s41 offen
    buffer_store_dwordx4 v[100:103], v4, s[32:35], s41 offen offset:16
    buffer_store_dwordx2 v[104:105], v4, s[32:35], s41 offen offset:32
K_END:
    s_endpgm
.section .rodata,"a"
.p2align 6
.amdhsa_kernel gated_mix__sliding_local_dilated__mha_block__prompt_kernel
  .amdhsa_next_free_vgpr 256
  .amdhsa_next_free_sgpr 76
  .amdhsa_accum_offset 256
  .amdhsa_group_segment_fixed_size 0
  .amdhsa_kernarg_size 80
  .amdhsa_user_sgpr_count 2
  .amdhsa_user_sgpr_kernarg_segment_ptr 1
  .amdhsa_system_sgpr_workgroup_id_x 1
.end_amdhsa_kernel
```
